```python
import torch

def _softmax(x, axis=-1):
    return torch.softmax(x, dim=axis)
def _gelu(x):
    return torch.nn.functional.gelu(x, approximate="tanh")
def _silu(x):
    return torch.nn.functional.silu(x)
def _sigmoid(x):
    return torch.sigmoid(x)
def _layernorm(x, axis=-1, eps=1e-5):
    m = x.mean(dim=axis, keepdim=True)
    v = x.var(dim=axis, keepdim=True, unbiased=False)
    return (x - m) / torch.sqrt(v + eps)
def _scatter_add(tgt, idx, src, axis=0):
    return tgt.clone().index_add_(axis, idx, src)
def _segment_sum(src, seg, n):
    out = torch.zeros((n,) + src.shape[1:], dtype=src.dtype)
    return out.index_add_(0, seg, src)
def _pad(x, pw):
    flat = tuple(v for pair in reversed(pw) for v in pair)
    return torch.nn.functional.pad(x, flat)

kernel_name = 'gated_mix__grouped_kv_mqa__grouped_kv_mqa__prompt'

def setup_inputs():

    _w = (lambda a: (lambda t: t.to(torch.bfloat16) if t.is_floating_point() else t)(torch.as_tensor(a)))
    def _A_setup():
        B, S, D, H = 1, 2048, 512, 32
        Dh = D // H
        return {
            "x": _w((lambda *s: torch.randn(*s, dtype=torch.bfloat16) * 0.05)(B, S, D)),
            "wq": _w((lambda *s: torch.randn(*s, dtype=torch.bfloat16) * 0.8)(D, H * Dh)),
            "wk": _w((lambda *s: torch.randn(*s, dtype=torch.bfloat16) * 0.8)(D, Dh)),
            "wv": _w((lambda *s: torch.randn(*s, dtype=torch.bfloat16) * 0.05)(D, Dh)),
            "wo": _w((lambda *s: torch.randn(*s, dtype=torch.bfloat16) * 0.05)(H * Dh, D)),
        }
    _A_in = _A_setup()

    def _B_setup():
        B, S, D, H = 1, 2048, 512, 32
        Dh = D // H
        return {
            "x": _w((lambda *s: torch.randn(*s, dtype=torch.bfloat16) * 0.05)(B, S, D)),
            "wq": _w((lambda *s: torch.randn(*s, dtype=torch.bfloat16) * 0.8)(D, H * Dh)),
            "wk": _w((lambda *s: torch.randn(*s, dtype=torch.bfloat16) * 0.8)(D, Dh)),
            "wv": _w((lambda *s: torch.randn(*s, dtype=torch.bfloat16) * 0.05)(D, Dh)),
            "wo": _w((lambda *s: torch.randn(*s, dtype=torch.bfloat16) * 0.05)(H * Dh, D)),
        }
    _B_in = _B_setup()

    return {
        "A_x": _A_in["x"],
        "A_wq": _A_in["wq"],
        "A_wk": _A_in["wk"],
        "A_wv": _A_in["wv"],
        "A_wo": _A_in["wo"],
        "B_x": _B_in["x"],
        "B_wq": _B_in["wq"],
        "B_wk": _B_in["wk"],
        "B_wv": _B_in["wv"],
        "B_wo": _B_in["wo"],
        "gate_w": _w((lambda *s: torch.randn(*s, dtype=torch.bfloat16) * 0.05)(512) * 16.0),
    }

def reference(A_x, A_wq, A_wk, A_wv, A_wo, B_x, B_wq, B_wk, B_wv, B_wo, gate_w):
    def _A_ref(x, wq, wk, wv, wo):
        B, S, D = x.shape
        H = 32
        Dh = D // H
        q = (lambda x, *d: x.permute(*d))((x @ wq).reshape(B, S, H, Dh), 0, 2, 1, 3)
        k = x @ wk
        v = x @ wv
        scores = torch.einsum("bhqd,bkd->bhqk", q, k) * (Dh ** -0.5)
        p = _softmax(scores, axis=-1)
        o = torch.einsum("bhqk,bkd->bhqd", p, v)
        return (lambda x, *d: x.permute(*d))(o, 0, 2, 1, 3).reshape(B, S, H * Dh) @ wo

    def _B_ref(x, wq, wk, wv, wo):
        B, S, D = x.shape
        H = 32
        Dh = D // H
        q = (lambda x, *d: x.permute(*d))((x @ wq).reshape(B, S, H, Dh), 0, 2, 1, 3)
        k = x @ wk
        v = x @ wv
        scores = torch.einsum("bhqd,bkd->bhqk", q, k) * (Dh ** -0.5)
        p = _softmax(scores, axis=-1)
        o = torch.einsum("bhqk,bkd->bhqd", p, v)
        return (lambda x, *d: x.permute(*d))(o, 0, 2, 1, 3).reshape(B, S, H * Dh) @ wo

    x = A_x
    g = _sigmoid((x * gate_w).sum(-1, keepdims=True))
    a = _A_ref(x, A_wq, A_wk, A_wv, A_wo)
    b = _B_ref(x, B_wq, B_wk, B_wv, B_wo)
    return g * a + (1 - g) * b
```

```asm
; @launch grid=(256,1,1) block=(512,1,1) lds=163840
.amdgcn_target "amdgcn-amd-amdhsa--gfx950"
.text
.globl gated_mix__grouped_kv_mqa__grouped_kv_mqa__prompt_kernel
.p2align 8
.type gated_mix__grouped_kv_mqa__grouped_kv_mqa__prompt_kernel,@function
gated_mix__grouped_kv_mqa__grouped_kv_mqa__prompt_kernel:
    s_cmp_ge_u32 s2, 256
    s_cbranch_scc1 L_end
    s_load_dwordx8 s[4:11], s[0:1], 0
    s_load_dwordx2 s[12:13], s[0:1], 32
    s_load_dwordx8 s[16:23], s[0:1], 48
    s_load_dwordx8 s[24:31], s[0:1], 80
    v_lshrrev_b32 v12, 6, v0
    v_and_b32 v1, 63, v0
    v_readfirstlane_b32 s64, v12
    s_lshr_b32 s78, s2, 3
    s_and_b32 s68, s78, 7
    s_lshr_b32 s78, s78, 3
    s_and_b32 s79, s2, 7
    s_lshl_b32 s79, s79, 2
    s_add_u32 s67, s79, s78
    s_lshr_b32 s65, s68, 2
    s_and_b32 s66, s68, 3
    s_lshr_b32 s76, s66, 1
    s_and_b32 s71, s66, 1
    s_lshr_b32 s69, s64, 2
    s_and_b32 s70, s64, 3
    s_cmp_eq_u32 s69, s71
    s_cselect_b32 s75, 1, 0
    s_lshl_b32 s86, s67, 16
    s_lshl_b32 s78, s71, 2
    s_add_u32 s78, s78, 3
    s_cmp_eq_u32 s64, s78
    s_cselect_b32 s92, 1, 0
    s_mov_b32 s93, 0
    s_getreg_b32 s97, hwreg(HW_REG_XCC_ID, 0, 4)
    s_mov_b32 s99, 0
    s_mov_b32 s98, 0
    s_mov_b32 s87, 0
    s_mov_b32 s72, 0x0000ffff
    s_mov_b32 s73, 0x0000ffff
    s_mov_b32 s77, 0
    v_lshlrev_b32 v2, 4, v1
    v_lshrrev_b32 v16, 5, v1
    v_mov_b32 v240, 0
    v_mov_b32 v242, 0
    s_mov_b32 s94, 0
    s_mov_b32 s95, 0
    v_and_b32 v12, 31, v1
    s_lshl_b32 s78, s69, 5
    v_add_u32 v18, s78, v12
    v_lshlrev_b32 v18, 10, v18
    v_add_u32 v18, 49152, v18
    v_and_b32 v17, 15, v1
    v_xor_b32 v19, v16, v17
    v_lshlrev_b32 v19, 4, v19
    s_waitcnt lgkmcnt(0)
    s_cmp_eq_u32 s65, 0
    s_cselect_b32 s6, s6, s16
    s_cselect_b32 s7, s7, s17
    s_cselect_b32 s8, s8, s18
    s_cselect_b32 s9, s9, s19
    s_cselect_b32 s10, s10, s20
    s_cselect_b32 s11, s11, s21
    s_cmp_eq_u32 s76, 0
    s_cselect_b32 s8, s8, s10
    s_cselect_b32 s9, s9, s11
    s_mov_b32 s32, s4
    s_and_b32 s33, s5, 0xffff
    s_mov_b32 s34, 2097152
    s_mov_b32 s35, 0x20000
    s_mov_b32 s40, s8
    s_and_b32 s41, s9, 0xffff
    s_mov_b32 s42, 16384
    s_mov_b32 s43, 0x20000
    s_mov_b32 s48, s28
    s_and_b32 s49, s29, 0xffff
    s_mov_b32 s50, 256
    s_mov_b32 s51, 0x20000
    s_xor_b32 s78, s64, 3
    s_or_b32 s78, s2, s78
    s_cmp_eq_u32 s78, 0
    s_cbranch_scc0 L_nononce
    s_memrealtime s[90:91]
    s_waitcnt lgkmcnt(0)
    s_lshl_b32 s90, s90, 4
    s_or_b32 s90, s90, 0x10
    v_mov_b32 v13, s90
    v_mov_b32 v15, 128
    buffer_store_dword v13, v15, s[48:51], 0 offen sc1
L_nononce:
    s_lshl_b32 s80, s71, 5
    s_add_u32 s80, s80, s64
    s_add_u32 s78, s80, 0
    s_and_b32 s79, s78, 15
    v_xor_b32 v13, s79, v1
    v_lshlrev_b32 v13, 4, v13
    s_lshl_b32 s79, s78, 10
    s_add_u32 m0, s79, 49152
    s_add_u32 s79, s79, s86
    buffer_load_dwordx4 v13, s[32:35], s79 offen lds
    s_add_u32 s78, s80, 8
    s_and_b32 s79, s78, 15
    v_xor_b32 v13, s79, v1
    v_lshlrev_b32 v13, 4, v13
    s_lshl_b32 s79, s78, 10
    s_add_u32 m0, s79, 49152
    s_add_u32 s79, s79, s86
    buffer_load_dwordx4 v13, s[32:35], s79 offen lds
    s_add_u32 s78, s80, 16
    s_and_b32 s79, s78, 15
    v_xor_b32 v13, s79, v1
    v_lshlrev_b32 v13, 4, v13
    s_lshl_b32 s79, s78, 10
    s_add_u32 m0, s79, 49152
    s_add_u32 s79, s79, s86
    buffer_load_dwordx4 v13, s[32:35], s79 offen lds
    s_add_u32 s78, s80, 24
    s_and_b32 s79, s78, 15
    v_xor_b32 v13, s79, v1
    v_lshlrev_b32 v13, 4, v13
    s_lshl_b32 s79, s78, 10
    s_add_u32 m0, s79, 49152
    s_add_u32 s79, s79, s86
    buffer_load_dwordx4 v13, s[32:35], s79 offen lds
    s_lshl_b32 s79, s64, 11
    s_add_u32 m0, s79, 32768
    s_add_u32 s81, s79, 1024
    buffer_load_dwordx4 v2, s[40:43], s79 offen lds
    s_add_u32 m0, s81, 32768
    s_mov_b32 s60, s24
    s_and_b32 s61, s25, 0xffff
    s_mov_b32 s62, 1024
    s_mov_b32 s63, 0x20000
    buffer_load_dwordx4 v2, s[40:43], s81 offen lds
    s_mov_b32 s44, s30
    s_and_b32 s45, s31, 0xffff
    s_mov_b32 s46, 16777216
    s_mov_b32 s47, 0x20000
    s_cmp_eq_u32 s75, 1
    s_cbranch_scc0 L_wrole
    s_setprio 3
    s_mov_b32 m0, 16384
    v_lshrrev_b32 v12, 4, v1
    buffer_load_dwordx4 v2, s[60:63], 0 offen lds
    s_and_b32 s80, s70, 1
    s_lshl_b32 s78, s71, 5
    s_lshl_b32 s79, s80, 4
    s_add_u32 s78, s78, s79
    v_add_u32 v14, s78, v17
    v_lshlrev_b32 v14, 10, v14
    v_add_u32 v14, 49152, v14
    v_xor_b32 v15, v12, v17
    v_lshlrev_b32 v15, 4, v15
    s_mov_b32 s78, 0
    v_xad_u32 v20, v15, s78, v14
    s_mov_b32 s78, 64
    v_xad_u32 v21, v15, s78, v14
    s_mov_b32 s78, 128
    v_xad_u32 v22, v15, s78, v14
    s_mov_b32 s78, 192
    v_xad_u32 v23, v15, s78, v14
    v_lshrrev_b32 v35, 2, v17
    v_lshl_add_u32 v35, v12, 3, v35
    v_lshlrev_b32 v35, 5, v35
    v_and_b32 v15, 3, v17
    v_lshl_add_u32 v35, v15, 3, v35
    v_add_u32 v35, 32768, v35
    v_lshlrev_b32 v36, 4, v12
    v_add_u32 v36, 16384, v36
    v_and_b32 v14, 1, v12
    v_lshrrev_b32 v15, 1, v12
    s_cmp_eq_u32 s76, 0
    s_cbranch_scc0 L_sa_v
    v_and_b32 v37, 3, v17
    v_and_b32 v13, 4, v17
    v_lshl_add_u32 v37, v13, 1, v37
    v_and_b32 v13, 8, v17
    v_lshrrev_b32 v13, 1, v13
    v_add_u32 v37, v37, v13
    v_lshl_add_u32 v37, v14, 5, v37
    s_lshl_b32 s79, s80, 4
    v_add_u32 v37, s79, v37
    v_lshlrev_b32 v37, 4, v37
    s_branch L_sa_j
L_sa_v:
    v_lshl_add_u32 v37, v14, 4, v17
    v_lshlrev_b32 v37, 4, v37
    s_lshl_b32 s79, s80, 9
    s_add_u32 s79, s79, 1024
    v_add_u32 v37, s79, v37
L_sa_j:
    v_lshl_add_u32 v37, v15, 3, v37
    s_lshl_b32 s78, s67, 1
    s_add_u32 s78, s78, s71
    s_lshl_b32 s85, s78, 11
    s_lshl_b32 s81, s65, 17
    s_add_u32 s85, s85, s81
    s_lshl_b32 s84, s78, 7
    s_add_u32 s84, s84, 262144
    v_mov_b32 v15, 128
    buffer_load_dword v38, v15, s[48:51], 0 offen sc1
    s_waitcnt vmcnt(0)
    s_barrier
    s_cmp_ge_u32 s70, 2
    s_cbranch_scc1 L_kv_gate
    s_cmp_eq_u32 s76, 0
    s_cbranch_scc0 L_kv_v
    ds_read_b64_tr_b16 v[128:129], v35 offset:0
    ds_read_b64_tr_b16 v[130:131], v35 offset:128
    ds_read_b128 v[192:195], v20 offset:0
    ds_read_b64_tr_b16 v[132:133], v35 offset:1024
    ds_read_b64_tr_b16 v[134:135], v35 offset:1152
    ds_read_b128 v[196:199], v21 offset:0
    ds_read_b64_tr_b16 v[136:137], v35 offset:2048
    ds_read_b64_tr_b16 v[138:139], v35 offset:2176
    ds_read_b128 v[200:203], v22 offset:0
    ds_read_b64_tr_b16 v[140:141], v35 offset:3072
    ds_read_b64_tr_b16 v[142:143], v35 offset:3200
    ds_read_b128 v[204:207], v23 offset:0
    ds_read_b64_tr_b16 v[144:145], v35 offset:4096
    ds_read_b64_tr_b16 v[146:147], v35 offset:4224
    ds_read_b128 v[208:211], v20 offset:256
    s_waitcnt lgkmcnt(12)
    v_mfma_f32_16x16x32_bf16 v[60:63], v[128:131], v[192:195], 0
    ds_read_b64_tr_b16 v[148:149], v35 offset:5120
    ds_read_b64_tr_b16 v[150:151], v35 offset:5248
    ds_read_b128 v[212:215], v21 offset:256
    s_waitcnt lgkmcnt(12)
    v_mfma_f32_16x16x32_bf16 v[60:63], v[132:135], v[196:199], v[60:63]
    ds_read_b64_tr_b16 v[152:153], v35 offset:6144
    ds_read_b64_tr_b16 v[154:155], v35 offset:6272
    ds_read_b128 v[216:219], v22 offset:256
    s_waitcnt lgkmcnt(12)
    v_mfma_f32_16x16x32_bf16 v[60:63], v[136:139], v[200:203], v[60:63]
    ds_read_b64_tr_b16 v[156:157], v35 offset:7168
    ds_read_b64_tr_b16 v[158:159], v35 offset:7296
    ds_read_b128 v[220:223], v23 offset:256
    s_waitcnt lgkmcnt(12)
    v_mfma_f32_16x16x32_bf16 v[60:63], v[140:143], v[204:207], v[60:63]
    ds_read_b64_tr_b16 v[160:161], v35 offset:8192
    ds_read_b64_tr_b16 v[162:163], v35 offset:8320
    ds_read_b128 v[224:227], v20 offset:512
    s_waitcnt lgkmcnt(12)
    v_mfma_f32_16x16x32_bf16 v[60:63], v[144:147], v[208:211], v[60:63]
    ds_read_b64_tr_b16 v[164:165], v35 offset:9216
    ds_read_b64_tr_b16 v[166:167], v35 offset:9344
    ds_read_b128 v[228:231], v21 offset:512
    s_waitcnt lgkmcnt(12)
    v_mfma_f32_16x16x32_bf16 v[60:63], v[148:151], v[212:215], v[60:63]
    ds_read_b64_tr_b16 v[168:169], v35 offset:10240
    ds_read_b64_tr_b16 v[170:171], v35 offset:10368
    ds_read_b128 v[232:235], v22 offset:512
    s_waitcnt lgkmcnt(12)
    v_mfma_f32_16x16x32_bf16 v[60:63], v[152:155], v[216:219], v[60:63]
    ds_read_b64_tr_b16 v[172:173], v35 offset:11264
    ds_read_b64_tr_b16 v[174:175], v35 offset:11392
    ds_read_b128 v[236:239], v23 offset:512
    s_waitcnt lgkmcnt(12)
    v_mfma_f32_16x16x32_bf16 v[60:63], v[156:159], v[220:223], v[60:63]
    ds_read_b64_tr_b16 v[176:177], v35 offset:12288
    ds_read_b64_tr_b16 v[178:179], v35 offset:12416
    ds_read_b128 v[240:243], v20 offset:768
    s_waitcnt lgkmcnt(12)
    v_mfma_f32_16x16x32_bf16 v[60:63], v[160:163], v[224:227], v[60:63]
    ds_read_b64_tr_b16 v[180:181], v35 offset:13312
    ds_read_b64_tr_b16 v[182:183], v35 offset:13440
    ds_read_b128 v[244:247], v21 offset:768
    s_waitcnt lgkmcnt(12)
    v_mfma_f32_16x16x32_bf16 v[60:63], v[164:167], v[228:231], v[60:63]
    ds_read_b64_tr_b16 v[184:185], v35 offset:14336
    ds_read_b64_tr_b16 v[186:187], v35 offset:14464
    ds_read_b128 v[248:251], v22 offset:768
    s_waitcnt lgkmcnt(12)
    v_mfma_f32_16x16x32_bf16 v[60:63], v[168:171], v[232:235], v[60:63]
    ds_read_b64_tr_b16 v[188:189], v35 offset:15360
    ds_read_b64_tr_b16 v[190:191], v35 offset:15488
    ds_read_b128 v[252:255], v23 offset:768
    s_waitcnt lgkmcnt(12)
    v_mfma_f32_16x16x32_bf16 v[60:63], v[172:175], v[236:239], v[60:63]
    s_waitcnt lgkmcnt(9)
    v_mfma_f32_16x16x32_bf16 v[60:63], v[176:179], v[240:243], v[60:63]
    s_waitcnt lgkmcnt(6)
    v_mfma_f32_16x16x32_bf16 v[60:63], v[180:183], v[244:247], v[60:63]
    s_waitcnt lgkmcnt(3)
    v_mfma_f32_16x16x32_bf16 v[60:63], v[184:187], v[248:251], v[60:63]
    s_waitcnt lgkmcnt(0)
    v_mfma_f32_16x16x32_bf16 v[60:63], v[188:191], v[252:255], v[60:63]
    s_branch L_kv_st
L_kv_v:
    ds_read_b64_tr_b16 v[128:129], v35 offset:0
    ds_read_b64_tr_b16 v[130:131], v35 offset:128
    ds_read_b128 v[192:195], v20 offset:0
    ds_read_b64_tr_b16 v[132:133], v35 offset:1024
    ds_read_b64_tr_b16 v[134:135], v35 offset:1152
    ds_read_b128 v[196:199], v21 offset:0
    ds_read_b64_tr_b16 v[136:137], v35 offset:2048
    ds_read_b64_tr_b16 v[138:139], v35 offset:2176
    ds_read_b128 v[200:203], v22 offset:0
    ds_read_b64_tr_b16 v[140:141], v35 offset:3072
    ds_read_b64_tr_b16 v[142:143], v35 offset:3200
    ds_read_b128 v[204:207], v23 offset:0
    ds_read_b64_tr_b16 v[144:145], v35 offset:4096
    ds_read_b64_tr_b16 v[146:147], v35 offset:4224
    ds_read_b128 v[208:211], v20 offset:256
    s_waitcnt lgkmcnt(12)
    v_mfma_f32_16x16x32_bf16 v[60:63], v[192:195], v[128:131], 0
    ds_read_b64_tr_b16 v[148:149], v35 offset:5120
    ds_read_b64_tr_b16 v[150:151], v35 offset:5248
    ds_read_b128 v[212:215], v21 offset:256
    s_waitcnt lgkmcnt(12)
    v_mfma_f32_16x16x32_bf16 v[60:63], v[196:199], v[132:135], v[60:63]
    ds_read_b64_tr_b16 v[152:153], v35 offset:6144
    ds_read_b64_tr_b16 v[154:155], v35 offset:6272
    ds_read_b128 v[216:219], v22 offset:256
    s_waitcnt lgkmcnt(12)
    v_mfma_f32_16x16x32_bf16 v[60:63], v[200:203], v[136:139], v[60:63]
    ds_read_b64_tr_b16 v[156:157], v35 offset:7168
    ds_read_b64_tr_b16 v[158:159], v35 offset:7296
    ds_read_b128 v[220:223], v23 offset:256
    s_waitcnt lgkmcnt(12)
    v_mfma_f32_16x16x32_bf16 v[60:63], v[204:207], v[140:143], v[60:63]
    ds_read_b64_tr_b16 v[160:161], v35 offset:8192
    ds_read_b64_tr_b16 v[162:163], v35 offset:8320
    ds_read_b128 v[224:227], v20 offset:512
    s_waitcnt lgkmcnt(12)
    v_mfma_f32_16x16x32_bf16 v[60:63], v[208:211], v[144:147], v[60:63]
    ds_read_b64_tr_b16 v[164:165], v35 offset:9216
    ds_read_b64_tr_b16 v[166:167], v35 offset:9344
    ds_read_b128 v[228:231], v21 offset:512
    s_waitcnt lgkmcnt(12)
    v_mfma_f32_16x16x32_bf16 v[60:63], v[212:215], v[148:151], v[60:63]
    ds_read_b64_tr_b16 v[168:169], v35 offset:10240
    ds_read_b64_tr_b16 v[170:171], v35 offset:10368
    ds_read_b128 v[232:235], v22 offset:512
    s_waitcnt lgkmcnt(12)
    v_mfma_f32_16x16x32_bf16 v[60:63], v[216:219], v[152:155], v[60:63]
    ds_read_b64_tr_b16 v[172:173], v35 offset:11264
    ds_read_b64_tr_b16 v[174:175], v35 offset:11392
    ds_read_b128 v[236:239], v23 offset:512
    s_waitcnt lgkmcnt(12)
    v_mfma_f32_16x16x32_bf16 v[60:63], v[220:223], v[156:159], v[60:63]
    ds_read_b64_tr_b16 v[176:177], v35 offset:12288
    ds_read_b64_tr_b16 v[178:179], v35 offset:12416
    ds_read_b128 v[240:243], v20 offset:768
    s_waitcnt lgkmcnt(12)
    v_mfma_f32_16x16x32_bf16 v[60:63], v[224:227], v[160:163], v[60:63]
    ds_read_b64_tr_b16 v[180:181], v35 offset:13312
    ds_read_b64_tr_b16 v[182:183], v35 offset:13440
    ds_read_b128 v[244:247], v21 offset:768
    s_waitcnt lgkmcnt(12)
    v_mfma_f32_16x16x32_bf16 v[60:63], v[228:231], v[164:167], v[60:63]
    ds_read_b64_tr_b16 v[184:185], v35 offset:14336
    ds_read_b64_tr_b16 v[186:187], v35 offset:14464
    ds_read_b128 v[248:251], v22 offset:768
    s_waitcnt lgkmcnt(12)
    v_mfma_f32_16x16x32_bf16 v[60:63], v[232:235], v[168:171], v[60:63]
    ds_read_b64_tr_b16 v[188:189], v35 offset:15360
    ds_read_b64_tr_b16 v[190:191], v35 offset:15488
    ds_read_b128 v[252:255], v23 offset:768
    s_waitcnt lgkmcnt(12)
    v_mfma_f32_16x16x32_bf16 v[60:63], v[236:239], v[172:175], v[60:63]
    s_waitcnt lgkmcnt(9)
    v_mfma_f32_16x16x32_bf16 v[60:63], v[240:243], v[176:179], v[60:63]
    s_waitcnt lgkmcnt(6)
    v_mfma_f32_16x16x32_bf16 v[60:63], v[244:247], v[180:183], v[60:63]
    s_waitcnt lgkmcnt(3)
    v_mfma_f32_16x16x32_bf16 v[60:63], v[248:251], v[184:187], v[60:63]
    s_waitcnt lgkmcnt(0)
    v_mfma_f32_16x16x32_bf16 v[60:63], v[252:255], v[188:191], v[60:63]
L_kv_st:
    s_nop 7
    v_cvt_pk_bf16_f32 v64, v60, v61
    v_cvt_pk_bf16_f32 v65, v62, v63
    buffer_store_dwordx2 v[64:65], v37, s[44:47], s85 offen sc1
    s_branch L_kv_sig
L_kv_gate:
    s_or_b32 s78, s76, s65
    s_xor_b32 s79, s70, 2
    s_or_b32 s78, s78, s79
    s_cmp_eq_u32 s78, 0
    s_cbranch_scc0 L_kv_idle
    v_add_u32 v24, 16384, v20
    v_add_u32 v25, 16384, v21
    v_add_u32 v26, 16384, v22
    v_add_u32 v27, 16384, v23
    ds_read_b128 v[128:131], v36 offset:0
    ds_read_b128 v[192:195], v20 offset:0
    ds_read_b128 v[196:199], v24 offset:0
    ds_read_b128 v[132:135], v36 offset:64
    ds_read_b128 v[200:203], v21 offset:0
    ds_read_b128 v[204:207], v25 offset:0
    ds_read_b128 v[136:139], v36 offset:128
    ds_read_b128 v[208:211], v22 offset:0
    ds_read_b128 v[212:215], v26 offset:0
    ds_read_b128 v[140:143], v36 offset:192
    ds_read_b128 v[216:219], v23 offset:0
    ds_read_b128 v[220:223], v27 offset:0
    ds_read_b128 v[144:147], v36 offset:256
    ds_read_b128 v[224:227], v20 offset:256
    ds_read_b128 v[228:231], v24 offset:256
    s_waitcnt lgkmcnt(12)
    v_mfma_f32_16x16x32_bf16 v[60:63], v[128:131], v[192:195], 0
    v_mfma_f32_16x16x32_bf16 v[64:67], v[128:131], v[196:199], 0
    ds_read_b128 v[148:151], v36 offset:320
    ds_read_b128 v[232:235], v21 offset:256
    ds_read_b128 v[236:239], v25 offset:256
    s_waitcnt lgkmcnt(12)
    v_mfma_f32_16x16x32_bf16 v[60:63], v[132:135], v[200:203], v[60:63]
    v_mfma_f32_16x16x32_bf16 v[64:67], v[132:135], v[204:207], v[64:67]
    ds_read_b128 v[152:155], v36 offset:384
    ds_read_b128 v[240:243], v22 offset:256
    ds_read_b128 v[244:247], v26 offset:256
    s_waitcnt lgkmcnt(12)
    v_mfma_f32_16x16x32_bf16 v[60:63], v[136:139], v[208:211], v[60:63]
    v_mfma_f32_16x16x32_bf16 v[64:67], v[136:139], v[212:215], v[64:67]
    ds_read_b128 v[156:159], v36 offset:448
    ds_read_b128 v[248:251], v23 offset:256
    ds_read_b128 v[252:255], v27 offset:256
    s_waitcnt lgkmcnt(12)
    v_mfma_f32_16x16x32_bf16 v[60:63], v[140:143], v[216:219], v[60:63]
    v_mfma_f32_16x16x32_bf16 v[64:67], v[140:143], v[220:223], v[64:67]
    ds_read_b128 v[128:131], v36 offset:512
    ds_read_b128 v[192:195], v20 offset:512
    ds_read_b128 v[196:199], v24 offset:512
    s_waitcnt lgkmcnt(12)
    v_mfma_f32_16x16x32_bf16 v[60:63], v[144:147], v[224:227], v[60:63]
    v_mfma_f32_16x16x32_bf16 v[64:67], v[144:147], v[228:231], v[64:67]
    ds_read_b128 v[132:135], v36 offset:576
    ds_read_b128 v[200:203], v21 offset:512
    ds_read_b128 v[204:207], v25 offset:512
    s_waitcnt lgkmcnt(12)
    v_mfma_f32_16x16x32_bf16 v[60:63], v[148:151], v[232:235], v[60:63]
    v_mfma_f32_16x16x32_bf16 v[64:67], v[148:151], v[236:239], v[64:67]
    ds_read_b128 v[136:139], v36 offset:640
    ds_read_b128 v[208:211], v22 offset:512
    ds_read_b128 v[212:215], v26 offset:512
    s_waitcnt lgkmcnt(12)
    v_mfma_f32_16x16x32_bf16 v[60:63], v[152:155], v[240:243], v[60:63]
    v_mfma_f32_16x16x32_bf16 v[64:67], v[152:155], v[244:247], v[64:67]
    ds_read_b128 v[140:143], v36 offset:704
    ds_read_b128 v[216:219], v23 offset:512
    ds_read_b128 v[220:223], v27 offset:512
    s_waitcnt lgkmcnt(12)
    v_mfma_f32_16x16x32_bf16 v[60:63], v[156:159], v[248:251], v[60:63]
    v_mfma_f32_16x16x32_bf16 v[64:67], v[156:159], v[252:255], v[64:67]
    ds_read_b128 v[144:147], v36 offset:768
    ds_read_b128 v[224:227], v20 offset:768
    ds_read_b128 v[228:231], v24 offset:768
    s_waitcnt lgkmcnt(12)
    v_mfma_f32_16x16x32_bf16 v[60:63], v[128:131], v[192:195], v[60:63]
    v_mfma_f32_16x16x32_bf16 v[64:67], v[128:131], v[196:199], v[64:67]
    ds_read_b128 v[148:151], v36 offset:832
    ds_read_b128 v[232:235], v21 offset:768
    ds_read_b128 v[236:239], v25 offset:768
    s_waitcnt lgkmcnt(12)
    v_mfma_f32_16x16x32_bf16 v[60:63], v[132:135], v[200:203], v[60:63]
    v_mfma_f32_16x16x32_bf16 v[64:67], v[132:135], v[204:207], v[64:67]
    ds_read_b128 v[152:155], v36 offset:896
    ds_read_b128 v[240:243], v22 offset:768
    ds_read_b128 v[244:247], v26 offset:768
    s_waitcnt lgkmcnt(12)
    v_mfma_f32_16x16x32_bf16 v[60:63], v[136:139], v[208:211], v[60:63]
    v_mfma_f32_16x16x32_bf16 v[64:67], v[136:139], v[212:215], v[64:67]
    ds_read_b128 v[156:159], v36 offset:960
    ds_read_b128 v[248:251], v23 offset:768
    ds_read_b128 v[252:255], v27 offset:768
    s_waitcnt lgkmcnt(12)
    v_mfma_f32_16x16x32_bf16 v[60:63], v[140:143], v[216:219], v[60:63]
    v_mfma_f32_16x16x32_bf16 v[64:67], v[140:143], v[220:223], v[64:67]
    s_waitcnt lgkmcnt(9)
    v_mfma_f32_16x16x32_bf16 v[60:63], v[144:147], v[224:227], v[60:63]
    v_mfma_f32_16x16x32_bf16 v[64:67], v[144:147], v[228:231], v[64:67]
    s_waitcnt lgkmcnt(6)
    v_mfma_f32_16x16x32_bf16 v[60:63], v[148:151], v[232:235], v[60:63]
    v_mfma_f32_16x16x32_bf16 v[64:67], v[148:151], v[236:239], v[64:67]
    s_waitcnt lgkmcnt(3)
    v_mfma_f32_16x16x32_bf16 v[60:63], v[152:155], v[240:243], v[60:63]
    v_mfma_f32_16x16x32_bf16 v[64:67], v[152:155], v[244:247], v[64:67]
    s_waitcnt lgkmcnt(0)
    v_mfma_f32_16x16x32_bf16 v[60:63], v[156:159], v[248:251], v[60:63]
    v_mfma_f32_16x16x32_bf16 v[64:67], v[156:159], v[252:255], v[64:67]
    v_and_b32 v13, 16, v1
    v_cmp_eq_u32 vcc, 0, v13
    s_nop 6
    v_cndmask_b32 v68, v64, v60, vcc
    v_cvt_pk_bf16_f32 v68, v68, v68
    v_lshlrev_b32 v68, 16, v68
    s_mov_b32 s80, 0xbfb8aa3b
    v_mul_f32 v68, s80, v68
    v_exp_f32 v68, v68
    s_nop 0
    v_add_f32 v68, 1.0, v68
    v_rcp_f32 v68, v68
    s_nop 0
    v_cvt_pk_bf16_f32 v68, v68, v68
    v_lshlrev_b32 v68, 16, v68
    v_lshlrev_b32 v69, 2, v1
    v_cmp_gt_u32 vcc, 32, v1
    s_and_saveexec_b64 s[82:83], vcc
    buffer_store_dword v68, v69, s[44:47], s84 offen sc1
    s_mov_b64 exec, s[82:83]
L_kv_sig:
    s_mov_b32 s78, 0
    v_xad_u32 v20, v19, s78, v18
    s_mov_b32 s78, 32
    v_xad_u32 v21, v19, s78, v18
    s_mov_b32 s78, 64
    v_xad_u32 v22, v19, s78, v18
    s_mov_b32 s78, 96
    v_xad_u32 v23, v19, s78, v18
    s_mov_b32 s78, 128
    v_xad_u32 v24, v19, s78, v18
    s_mov_b32 s78, 160
    v_xad_u32 v25, v19, s78, v18
    s_mov_b32 s78, 192
    v_xad_u32 v26, v19, s78, v18
    s_mov_b32 s78, 224
    v_xad_u32 v27, v19, s78, v18
    v_lshrrev_b32 v12, 4, v1
    v_lshrrev_b32 v15, 2, v17
    v_lshl_add_u32 v28, v16, 3, v15
    v_lshlrev_b32 v28, 8, v28
    v_and_b32 v29, 1, v12
    v_lshlrev_b32 v29, 1, v29
    v_bfe_u32 v30, v17, 1, 1
    v_add_u32 v29, v29, v30
    s_lshl_b32 s79, s70, 2
    v_add_u32 v29, s79, v29
    v_lshlrev_b32 v15, 2, v15
    v_xor_b32 v29, v29, v15
    v_lshl_add_u32 v28, v29, 4, v28
    v_and_b32 v30, 1, v17
    v_lshl_add_u32 v28, v30, 3, v28
    v_add_u32 v33, 16384, v28
    v_add_u32 v32, 32768, v28
    v_add_u32 v31, 147456, v28
    v_add_u32 v30, 131072, v28
    v_add_u32 v29, 114688, v28
    s_cmp_eq_u32 s69, 0
    s_cselect_b32 s12, s12, s22
    s_cselect_b32 s13, s13, s23
    s_mov_b32 s56, s26
    s_and_b32 s57, s27, 0xffff
    s_mov_b32 s58, 2097152
    s_mov_b32 s59, 0x20000
    s_mov_b32 s52, s12
    s_and_b32 s53, s13, 0xffff
    s_mov_b32 s54, 524288
    s_mov_b32 s55, 0x20000
    v_lshl_add_u32 v3, v16, 4, v17
    v_lshlrev_b32 v3, 4, v3
    s_mov_b32 s87, 1
    s_branch L_sigcode
L_kv_idle:
    s_lshl_b32 s78, s67, 16
    v_mov_b32 v241, s78
    global_load_dword v244, v241, s[26:27]
    s_lshl_b32 s78, s67, 17
    s_add_u32 s78, s78, 1048576
    v_mov_b32 v241, s78
    global_load_dword v245, v241, s[30:31]
    s_lshr_b32 s78, s68, 1
    s_lshl_b32 s78, s78, 8
    v_mov_b32 v241, s78
    global_load_dword v246, v241, s[12:13]
    global_load_dword v247, v241, s[22:23]
    s_mov_b32 s78, 0
    v_xad_u32 v20, v19, s78, v18
    s_mov_b32 s78, 32
    v_xad_u32 v21, v19, s78, v18
    s_mov_b32 s78, 64
    v_xad_u32 v22, v19, s78, v18
    s_mov_b32 s78, 96
    v_xad_u32 v23, v19, s78, v18
    s_mov_b32 s78, 128
    v_xad_u32 v24, v19, s78, v18
    s_mov_b32 s78, 160
    v_xad_u32 v25, v19, s78, v18
    s_mov_b32 s78, 192
    v_xad_u32 v26, v19, s78, v18
    s_mov_b32 s78, 224
    v_xad_u32 v27, v19, s78, v18
    v_lshrrev_b32 v12, 4, v1
    v_lshrrev_b32 v15, 2, v17
    v_lshl_add_u32 v28, v16, 3, v15
    v_lshlrev_b32 v28, 8, v28
    v_and_b32 v29, 1, v12
    v_lshlrev_b32 v29, 1, v29
    v_bfe_u32 v30, v17, 1, 1
    v_add_u32 v29, v29, v30
    s_lshl_b32 s79, s70, 2
    v_add_u32 v29, s79, v29
    v_lshlrev_b32 v15, 2, v15
    v_xor_b32 v29, v29, v15
    v_lshl_add_u32 v28, v29, 4, v28
    v_and_b32 v30, 1, v17
    v_lshl_add_u32 v28, v30, 3, v28
    v_add_u32 v33, 16384, v28
    v_add_u32 v32, 32768, v28
    v_add_u32 v31, 147456, v28
    v_add_u32 v30, 131072, v28
    v_add_u32 v29, 114688, v28
    s_cmp_eq_u32 s69, 0
    s_cselect_b32 s12, s12, s22
    s_cselect_b32 s13, s13, s23
    s_mov_b32 s56, s26
    s_and_b32 s57, s27, 0xffff
    s_mov_b32 s58, 2097152
    s_mov_b32 s59, 0x20000
    s_mov_b32 s52, s12
    s_and_b32 s53, s13, 0xffff
    s_mov_b32 s54, 524288
    s_mov_b32 s55, 0x20000
    v_lshl_add_u32 v3, v16, 4, v17
    v_lshlrev_b32 v3, 4, v3
    v_lshrrev_b32 v240, 1, v1
    v_lshlrev_b32 v240, 7, v240
    v_and_b32 v242, 1, v1
    v_lshl_add_u32 v240, v242, 4, v240
    v_lshlrev_b32 v242, 2, v242
    s_lshl_b32 s94, s65, 12
    s_add_u32 s94, s94, 532480
    s_lshl_b32 s95, s67, 7
    s_add_u32 s95, s95, 540672
    v_readfirstlane_b32 s77, v38
    s_branch L_b1
L_sigcode:
    s_cmp_eq_u32 s87, 1
    s_cbranch_scc0 L_nosig
    v_readfirstlane_b32 s77, v38
    s_mov_b32 s79, 0
L_nwait:
    s_cmp_lg_u32 s77, 0
    s_cbranch_scc1 L_nok
    v_mov_b32 v15, 128
    buffer_load_dword v38, v15, s[48:51], 0 offen sc1
    s_waitcnt vmcnt(0)
    v_readfirstlane_b32 s77, v38
    s_add_u32 s79, s79, 1
    s_cmp_lt_u32 s79, 8192
    s_cbranch_scc1 L_nwait
L_nok:
    s_cmp_eq_u32 s70, 2
    s_cbranch_scc1 L_fa_gate
    s_lshl_b32 s78, s65, 5
    s_add_u32 s78, s78, s67
    s_lshl_b32 s78, s78, 7
    s_lshl_b32 s79, s71, 2
    s_lshl_b32 s80, s76, 1
    s_add_u32 s79, s79, s80
    s_add_u32 s79, s79, s70
    s_lshl_b32 s79, s79, 2
    s_add_u32 s78, s78, s79
    s_add_u32 s78, s78, 532480
    s_branch L_fa_j
L_fa_gate:
    s_lshl_b32 s78, s67, 7
    s_lshl_b32 s79, s71, 2
    s_add_u32 s78, s78, s79
    s_add_u32 s78, s78, 540672
L_fa_j:
    v_mov_b32 v200, 0
    v_mov_b32 v201, s77
    s_waitcnt vmcnt(0)
    v_cmp_eq_u32 vcc, 0, v1
    s_and_saveexec_b64 s[82:83], vcc
    buffer_store_dword v201, v200, s[44:47], s78 offen sc1
    s_mov_b64 exec, s[82:83]
L_nosig:
    s_branch L_b1
L_wrole:
    v_lshrrev_b32 v12, 4, v1
    v_lshlrev_b32 v34, 2, v12
    v_xor_b32 v34, v34, v17
    v_lshlrev_b32 v34, 4, v34
    v_lshl_add_u32 v34, v12, 10, v34
    s_lshl_b32 s79, s66, 8
    v_add_u32 v34, s79, v34
    s_mov_b32 s36, s6
    s_and_b32 s37, s7, 0xffff
    s_mov_b32 s38, 524288
    s_mov_b32 s39, 0x20000
    s_mov_b32 s78, 0
    v_xad_u32 v20, v19, s78, v18
    s_mov_b32 s78, 32
    v_xad_u32 v21, v19, s78, v18
    s_mov_b32 s78, 64
    v_xad_u32 v22, v19, s78, v18
    s_mov_b32 s78, 96
    v_xad_u32 v23, v19, s78, v18
    s_mov_b32 s78, 128
    v_xad_u32 v24, v19, s78, v18
    s_mov_b32 s78, 160
    v_xad_u32 v25, v19, s78, v18
    s_mov_b32 s78, 192
    v_xad_u32 v26, v19, s78, v18
    s_mov_b32 s78, 224
    v_xad_u32 v27, v19, s78, v18
    v_lshrrev_b32 v12, 4, v1
    v_lshrrev_b32 v15, 2, v17
    v_lshl_add_u32 v28, v16, 3, v15
    v_lshlrev_b32 v28, 8, v28
    v_and_b32 v29, 1, v12
    v_lshlrev_b32 v29, 1, v29
    v_bfe_u32 v30, v17, 1, 1
    v_add_u32 v29, v29, v30
    s_lshl_b32 s79, s70, 2
    v_add_u32 v29, s79, v29
    v_lshlrev_b32 v15, 2, v15
    v_xor_b32 v29, v29, v15
    v_lshl_add_u32 v28, v29, 4, v28
    v_and_b32 v30, 1, v17
    v_lshl_add_u32 v28, v30, 3, v28
    v_add_u32 v33, 16384, v28
    v_add_u32 v32, 32768, v28
    v_add_u32 v31, 147456, v28
    v_add_u32 v30, 131072, v28
    v_add_u32 v29, 114688, v28
    s_cmp_eq_u32 s69, 0
    s_cselect_b32 s12, s12, s22
    s_cselect_b32 s13, s13, s23
    s_mov_b32 s56, s26
    s_and_b32 s57, s27, 0xffff
    s_mov_b32 s58, 2097152
    s_mov_b32 s59, 0x20000
    s_mov_b32 s52, s12
    s_and_b32 s53, s13, 0xffff
    s_mov_b32 s54, 524288
    s_mov_b32 s55, 0x20000
    v_lshl_add_u32 v3, v16, 4, v17
    v_lshlrev_b32 v3, 4, v3
    s_waitcnt vmcnt(0)
    s_barrier
    s_xor_b32 s80, s71, 1
    s_lshl_b32 s80, s80, 5
    s_add_u32 s80, s80, s70
    s_add_u32 s78, s80, 0
    s_and_b32 s79, s78, 15
    v_xor_b32 v13, s79, v1
    v_lshlrev_b32 v13, 4, v13
    s_lshl_b32 s79, s78, 10
    s_add_u32 m0, s79, 49152
    s_add_u32 s79, s79, s86
    buffer_load_dwordx4 v13, s[32:35], s79 offen lds
    s_add_u32 s78, s80, 4
    s_and_b32 s79, s78, 15
    v_xor_b32 v13, s79, v1
    v_lshlrev_b32 v13, 4, v13
    s_lshl_b32 s79, s78, 10
    s_add_u32 m0, s79, 49152
    s_add_u32 s79, s79, s86
    buffer_load_dwordx4 v13, s[32:35], s79 offen lds
    s_add_u32 s78, s80, 8
    s_and_b32 s79, s78, 15
    v_xor_b32 v13, s79, v1
    v_lshlrev_b32 v13, 4, v13
    s_lshl_b32 s79, s78, 10
    s_add_u32 m0, s79, 49152
    s_add_u32 s79, s79, s86
    buffer_load_dwordx4 v13, s[32:35], s79 offen lds
    s_add_u32 s78, s80, 12
    s_and_b32 s79, s78, 15
    v_xor_b32 v13, s79, v1
    v_lshlrev_b32 v13, 4, v13
    s_lshl_b32 s79, s78, 10
    s_add_u32 m0, s79, 49152
    s_add_u32 s79, s79, s86
    buffer_load_dwordx4 v13, s[32:35], s79 offen lds
    s_add_u32 s78, s80, 16
    s_and_b32 s79, s78, 15
    v_xor_b32 v13, s79, v1
    v_lshlrev_b32 v13, 4, v13
    s_lshl_b32 s79, s78, 10
    s_add_u32 m0, s79, 49152
    s_add_u32 s79, s79, s86
    buffer_load_dwordx4 v13, s[32:35], s79 offen lds
    s_add_u32 s78, s80, 20
    s_and_b32 s79, s78, 15
    v_xor_b32 v13, s79, v1
    v_lshlrev_b32 v13, 4, v13
    s_lshl_b32 s79, s78, 10
    s_add_u32 m0, s79, 49152
    s_add_u32 s79, s79, s86
    buffer_load_dwordx4 v13, s[32:35], s79 offen lds
    s_add_u32 s78, s80, 24
    s_and_b32 s79, s78, 15
    v_xor_b32 v13, s79, v1
    v_lshlrev_b32 v13, 4, v13
    s_lshl_b32 s79, s78, 10
    s_add_u32 m0, s79, 49152
    s_add_u32 s79, s79, s86
    buffer_load_dwordx4 v13, s[32:35], s79 offen lds
    s_add_u32 s78, s80, 28
    s_and_b32 s79, s78, 15
    v_xor_b32 v13, s79, v1
    v_lshlrev_b32 v13, 4, v13
    s_lshl_b32 s79, s78, 10
    s_add_u32 m0, s79, 49152
    s_add_u32 s79, s79, s86
    buffer_load_dwordx4 v13, s[32:35], s79 offen lds
    s_lshl_b32 s79, s70, 12
    s_add_u32 m0, s79, 0
    s_lshl_b32 s79, s70, 14
    s_add_u32 s79, s79, 0
    buffer_load_dwordx4 v34, s[36:39], s79 offen lds
    s_lshl_b32 s79, s70, 12
    s_add_u32 m0, s79, 1024
    s_lshl_b32 s79, s70, 14
    s_add_u32 s79, s79, 4096
    buffer_load_dwordx4 v34, s[36:39], s79 offen lds
    s_lshl_b32 s79, s70, 12
    s_add_u32 m0, s79, 2048
    s_lshl_b32 s79, s70, 14
    s_add_u32 s79, s79, 8192
    buffer_load_dwordx4 v34, s[36:39], s79 offen lds
    s_lshl_b32 s79, s70, 12
    s_add_u32 m0, s79, 3072
    s_lshl_b32 s79, s70, 14
    s_add_u32 s79, s79, 12288
    buffer_load_dwordx4 v34, s[36:39], s79 offen lds
    s_lshl_b32 s79, s70, 12
    s_add_u32 m0, s79, 114688
    s_lshl_b32 s79, s70, 14
    s_add_u32 s79, s79, 65536
    buffer_load_dwordx4 v34, s[36:39], s79 offen lds
    s_lshl_b32 s79, s70, 12
    s_add_u32 m0, s79, 115712
    s_lshl_b32 s79, s70, 14
    s_add_u32 s79, s79, 69632
    buffer_load_dwordx4 v34, s[36:39], s79 offen lds
    s_lshl_b32 s79, s70, 12
    s_add_u32 m0, s79, 116736
    s_lshl_b32 s79, s70, 14
    s_add_u32 s79, s79, 73728
    buffer_load_dwordx4 v34, s[36:39], s79 offen lds
    s_lshl_b32 s79, s70, 12
    s_add_u32 m0, s79, 117760
    s_lshl_b32 s79, s70, 14
    s_add_u32 s79, s79, 77824
    buffer_load_dwordx4 v34, s[36:39], s79 offen lds
    s_lshl_b32 s79, s70, 12
    s_add_u32 m0, s79, 131072
    s_lshl_b32 s79, s70, 14
    s_add_u32 s79, s79, 131072
    buffer_load_dwordx4 v34, s[36:39], s79 offen lds
    s_lshl_b32 s79, s70, 12
    s_add_u32 m0, s79, 132096
    s_lshl_b32 s79, s70, 14
    s_add_u32 s79, s79, 135168
    buffer_load_dwordx4 v34, s[36:39], s79 offen lds
    s_lshl_b32 s79, s70, 12
    s_add_u32 m0, s79, 133120
    s_lshl_b32 s79, s70, 14
    s_add_u32 s79, s79, 139264
    buffer_load_dwordx4 v34, s[36:39], s79 offen lds
    s_lshl_b32 s79, s70, 12
    s_add_u32 m0, s79, 134144
    s_lshl_b32 s79, s70, 14
    s_add_u32 s79, s79, 143360
    buffer_load_dwordx4 v34, s[36:39], s79 offen lds
    s_lshl_b32 s79, s70, 12
    s_add_u32 m0, s79, 147456
    s_lshl_b32 s79, s70, 14
    s_add_u32 s79, s79, 196608
    buffer_load_dwordx4 v34, s[36:39], s79 offen lds
    s_lshl_b32 s79, s70, 12
    s_add_u32 m0, s79, 148480
    s_lshl_b32 s79, s70, 14
    s_add_u32 s79, s79, 200704
    buffer_load_dwordx4 v34, s[36:39], s79 offen lds
    s_lshl_b32 s79, s70, 12
    s_add_u32 m0, s79, 149504
    s_lshl_b32 s79, s70, 14
    s_add_u32 s79, s79, 204800
    buffer_load_dwordx4 v34, s[36:39], s79 offen lds
    s_lshl_b32 s79, s70, 12
    s_add_u32 m0, s79, 150528
    s_lshl_b32 s79, s70, 14
    s_add_u32 s79, s79, 208896
    buffer_load_dwordx4 v34, s[36:39], s79 offen lds
    s_waitcnt vmcnt(8)
L_b1:
    s_setprio 0
    s_barrier
    ds_read_b64_tr_b16 v[76:77], v28 offset:0
    ds_read_b64_tr_b16 v[78:79], v28 offset:1024
    ds_read_b128 v[92:95], v20 offset:0
    ds_read_b64_tr_b16 v[80:81], v28 offset:4096
    ds_read_b64_tr_b16 v[82:83], v28 offset:5120
    ds_read_b128 v[96:99], v21 offset:0
    ds_read_b64_tr_b16 v[84:85], v28 offset:8192
    ds_read_b64_tr_b16 v[86:87], v28 offset:9216
    ds_read_b128 v[100:103], v22 offset:0
    ds_read_b64_tr_b16 v[88:89], v28 offset:12288
    ds_read_b64_tr_b16 v[90:91], v28 offset:13312
    ds_read_b128 v[104:107], v23 offset:0
    s_cmp_eq_u32 s75, 1
    s_cbranch_scc1 L_c5_skip
    s_lshl_b32 s79, s70, 12
    s_add_u32 m0, s79, 32768
    s_lshl_b32 s79, s70, 14
    s_add_u32 s79, s79, 262144
    buffer_load_dwordx4 v34, s[36:39], s79 offen lds
    s_lshl_b32 s79, s70, 12
    s_add_u32 m0, s79, 33792
    s_lshl_b32 s79, s70, 14
    s_add_u32 s79, s79, 266240
    buffer_load_dwordx4 v34, s[36:39], s79 offen lds
    s_lshl_b32 s79, s70, 12
    s_add_u32 m0, s79, 34816
    s_lshl_b32 s79, s70, 14
    s_add_u32 s79, s79, 270336
    buffer_load_dwordx4 v34, s[36:39], s79 offen lds
    s_lshl_b32 s79, s70, 12
    s_add_u32 m0, s79, 35840
    s_lshl_b32 s79, s70, 14
    s_add_u32 s79, s79, 274432
    buffer_load_dwordx4 v34, s[36:39], s79 offen lds
    s_lshl_b32 s79, s70, 12
    s_add_u32 m0, s79, 16384
    s_lshl_b32 s79, s70, 14
    s_add_u32 s79, s79, 327680
    buffer_load_dwordx4 v34, s[36:39], s79 offen lds
    s_lshl_b32 s79, s70, 12
    s_add_u32 m0, s79, 17408
    s_lshl_b32 s79, s70, 14
    s_add_u32 s79, s79, 331776
    buffer_load_dwordx4 v34, s[36:39], s79 offen lds
    s_lshl_b32 s79, s70, 12
    s_add_u32 m0, s79, 18432
    s_lshl_b32 s79, s70, 14
    s_add_u32 s79, s79, 335872
    buffer_load_dwordx4 v34, s[36:39], s79 offen lds
    s_lshl_b32 s79, s70, 12
    s_add_u32 m0, s79, 19456
    s_lshl_b32 s79, s70, 14
    s_add_u32 s79, s79, 339968
    buffer_load_dwordx4 v34, s[36:39], s79 offen lds
L_c5_skip:
    s_waitcnt lgkmcnt(9)
    v_mfma_f32_32x32x16_bf16 v[44:59], v[76:79], v[92:95], 0
    ds_read_b64_tr_b16 v[76:77], v29 offset:0
    ds_read_b64_tr_b16 v[78:79], v29 offset:1024
    ds_read_b128 v[92:95], v24 offset:0
    s_waitcnt lgkmcnt(9)
    v_mfma_f32_32x32x16_bf16 v[44:59], v[80:83], v[96:99], v[44:59]
    ds_read_b64_tr_b16 v[80:81], v29 offset:4096
    ds_read_b64_tr_b16 v[82:83], v29 offset:5120
    ds_read_b128 v[96:99], v25 offset:0
    s_waitcnt lgkmcnt(9)
    v_mfma_f32_32x32x16_bf16 v[44:59], v[84:87], v[100:103], v[44:59]
    ds_read_b64_tr_b16 v[84:85], v29 offset:8192
    ds_read_b64_tr_b16 v[86:87], v29 offset:9216
    ds_read_b128 v[100:103], v26 offset:0
    s_waitcnt lgkmcnt(9)
    v_mfma_f32_32x32x16_bf16 v[44:59], v[88:91], v[104:107], v[44:59]
    ds_read_b64_tr_b16 v[88:89], v29 offset:12288
    ds_read_b64_tr_b16 v[90:91], v29 offset:13312
    ds_read_b128 v[104:107], v27 offset:0
    s_waitcnt lgkmcnt(9)
    v_mfma_f32_32x32x16_bf16 v[44:59], v[76:79], v[92:95], v[44:59]
    s_waitcnt lgkmcnt(6)
    v_mfma_f32_32x32x16_bf16 v[44:59], v[80:83], v[96:99], v[44:59]
    s_waitcnt lgkmcnt(3)
    v_mfma_f32_32x32x16_bf16 v[44:59], v[84:87], v[100:103], v[44:59]
    s_waitcnt lgkmcnt(0)
    s_cmp_eq_u32 s75, 1
    s_cbranch_scc1 L_q0_kv
    s_waitcnt vmcnt(8)
    s_barrier
    s_lshl_b32 s79, s70, 12
    s_add_u32 m0, s79, 0
    s_lshl_b32 s79, s70, 14
    s_add_u32 s79, s79, 393216
    buffer_load_dwordx4 v34, s[36:39], s79 offen lds
    s_lshl_b32 s79, s70, 12
    s_add_u32 m0, s79, 1024
    s_lshl_b32 s79, s70, 14
    s_add_u32 s79, s79, 397312
    buffer_load_dwordx4 v34, s[36:39], s79 offen lds
    s_lshl_b32 s79, s70, 12
    s_add_u32 m0, s79, 2048
    s_lshl_b32 s79, s70, 14
    s_add_u32 s79, s79, 401408
    buffer_load_dwordx4 v34, s[36:39], s79 offen lds
    s_lshl_b32 s79, s70, 12
    s_add_u32 m0, s79, 3072
    s_lshl_b32 s79, s70, 14
    s_add_u32 s79, s79, 405504
    buffer_load_dwordx4 v34, s[36:39], s79 offen lds
    s_lshl_b32 s79, s70, 12
    s_add_u32 m0, s79, 114688
    s_lshl_b32 s79, s70, 14
    s_add_u32 s79, s79, 458752
    buffer_load_dwordx4 v34, s[36:39], s79 offen lds
    s_lshl_b32 s79, s70, 12
    s_add_u32 m0, s79, 115712
    s_lshl_b32 s79, s70, 14
    s_add_u32 s79, s79, 462848
    buffer_load_dwordx4 v34, s[36:39], s79 offen lds
    s_lshl_b32 s79, s70, 12
    s_add_u32 m0, s79, 116736
    s_lshl_b32 s79, s70, 14
    s_add_u32 s79, s79, 466944
    buffer_load_dwordx4 v34, s[36:39], s79 offen lds
    s_lshl_b32 s79, s70, 12
    s_add_u32 m0, s79, 117760
    s_lshl_b32 s79, s70, 14
    s_add_u32 s79, s79, 471040
    buffer_load_dwordx4 v34, s[36:39], s79 offen lds
    s_branch L_q0_j
L_q0_kv:
    s_barrier
L_q0_j:
    ds_read_b64_tr_b16 v[76:77], v30 offset:0
    ds_read_b64_tr_b16 v[78:79], v30 offset:1024
    ds_read_b128 v[92:95], v20 offset:256
    ds_read_b64_tr_b16 v[80:81], v30 offset:4096
    ds_read_b64_tr_b16 v[82:83], v30 offset:5120
    ds_read_b128 v[96:99], v21 offset:256
    ds_read_b64_tr_b16 v[84:85], v30 offset:8192
    ds_read_b64_tr_b16 v[86:87], v30 offset:9216
    ds_read_b128 v[100:103], v22 offset:256
    v_mfma_f32_32x32x16_bf16 v[44:59], v[88:91], v[104:107], v[44:59]
    ds_read_b64_tr_b16 v[88:89], v30 offset:12288
    ds_read_b64_tr_b16 v[90:91], v30 offset:13312
    ds_read_b128 v[104:107], v23 offset:256
    s_cmp_eq_u32 s92, 1
    s_cbranch_scc0 L_ps0
    s_cmp_eq_u32 s77, 0
    s_cbranch_scc1 L_xp0
    s_cmp_lg_u32 s99, 0
    s_cbranch_scc1 L_xp0
    s_or_b32 s99, s77, s97
    s_lshl_b32 s78, s67, 7
    s_lshl_b32 s79, s68, 2
    s_add_u32 s78, s78, s79
    s_add_u32 s78, s78, 548864
    v_mov_b32 v241, 0
    v_mov_b32 v249, s99
    buffer_store_dword v249, v241, s[44:47], s78 offen sc1
L_xp0:
    s_cmp_lg_u32 s93, 0
    s_cbranch_scc1 L_ps0_fok
    v_mov_b32 v241, 128
    buffer_load_dword v38, v241, s[48:51], 0 offen sc1
    buffer_load_dwordx4 v[244:247], v240, s[44:47], s94 offen sc1
    buffer_load_dword v248, v242, s[44:47], s95 offen sc1
    s_branch L_ps0
L_ps0_fok:
L_ps0:
    s_waitcnt lgkmcnt(9)
    v_mfma_f32_32x32x16_bf16 v[44:59], v[76:79], v[92:95], v[44:59]
    ds_read_b64_tr_b16 v[76:77], v31 offset:0
    ds_read_b64_tr_b16 v[78:79], v31 offset:1024
    ds_read_b128 v[92:95], v24 offset:256
    s_waitcnt lgkmcnt(9)
    v_mfma_f32_32x32x16_bf16 v[44:59], v[80:83], v[96:99], v[44:59]
    ds_read_b64_tr_b16 v[80:81], v31 offset:4096
    ds_read_b64_tr_b16 v[82:83], v31 offset:5120
    ds_read_b128 v[96:99], v25 offset:256
    s_waitcnt lgkmcnt(9)
    v_mfma_f32_32x32x16_bf16 v[44:59], v[84:87], v[100:103], v[44:59]
    ds_read_b64_tr_b16 v[84:85], v31 offset:8192
    ds_read_b64_tr_b16 v[86:87], v31 offset:9216
    ds_read_b128 v[100:103], v26 offset:256
    s_waitcnt lgkmcnt(9)
    v_mfma_f32_32x32x16_bf16 v[44:59], v[88:91], v[104:107], v[44:59]
    ds_read_b64_tr_b16 v[88:89], v31 offset:12288
    ds_read_b64_tr_b16 v[90:91], v31 offset:13312
    ds_read_b128 v[104:107], v27 offset:256
    s_waitcnt lgkmcnt(9)
    v_mfma_f32_32x32x16_bf16 v[44:59], v[76:79], v[92:95], v[44:59]
    s_waitcnt lgkmcnt(6)
    v_mfma_f32_32x32x16_bf16 v[44:59], v[80:83], v[96:99], v[44:59]
    s_waitcnt lgkmcnt(3)
    v_mfma_f32_32x32x16_bf16 v[44:59], v[84:87], v[100:103], v[44:59]
    s_waitcnt lgkmcnt(0)
    s_cmp_eq_u32 s75, 1
    s_cbranch_scc1 L_q1_kv
    s_waitcnt vmcnt(8)
    s_barrier
    s_branch L_q1_j
L_q1_kv:
    s_barrier
L_q1_j:
    ds_read_b64_tr_b16 v[76:77], v32 offset:0
    ds_read_b64_tr_b16 v[78:79], v32 offset:1024
    ds_read_b128 v[92:95], v20 offset:512
    ds_read_b64_tr_b16 v[80:81], v32 offset:4096
    ds_read_b64_tr_b16 v[82:83], v32 offset:5120
    ds_read_b128 v[96:99], v21 offset:512
    ds_read_b64_tr_b16 v[84:85], v32 offset:8192
    ds_read_b64_tr_b16 v[86:87], v32 offset:9216
    ds_read_b128 v[100:103], v22 offset:512
    v_mfma_f32_32x32x16_bf16 v[44:59], v[88:91], v[104:107], v[44:59]
    ds_read_b64_tr_b16 v[88:89], v32 offset:12288
    ds_read_b64_tr_b16 v[90:91], v32 offset:13312
    ds_read_b128 v[104:107], v23 offset:512
    s_cmp_eq_u32 s92, 1
    s_cbranch_scc0 L_ps1
    s_cmp_eq_u32 s77, 0
    s_cbranch_scc1 L_xp1
    s_cmp_lg_u32 s99, 0
    s_cbranch_scc1 L_xp1
    s_or_b32 s99, s77, s97
    s_lshl_b32 s78, s67, 7
    s_lshl_b32 s79, s68, 2
    s_add_u32 s78, s78, s79
    s_add_u32 s78, s78, 548864
    v_mov_b32 v241, 0
    v_mov_b32 v249, s99
    buffer_store_dword v249, v241, s[44:47], s78 offen sc1
L_xp1:
    s_cmp_lg_u32 s93, 0
    s_cbranch_scc1 L_ps1_fok
    s_waitcnt vmcnt(0)
    s_cmp_eq_u32 s77, 0
    s_cbranch_scc1 L_ps1_re
    v_cmp_eq_u32 vcc, s77, v244
    v_cmp_eq_u32 s[80:81], s77, v245
    s_and_b64 vcc, vcc, s[80:81]
    v_cmp_eq_u32 s[80:81], s77, v246
    s_and_b64 vcc, vcc, s[80:81]
    v_cmp_eq_u32 s[80:81], s77, v247
    s_and_b64 vcc, vcc, s[80:81]
    v_cmp_eq_u32 s[80:81], s77, v248
    s_and_b64 vcc, vcc, s[80:81]
    s_cmp_eq_u64 vcc, exec
    s_cbranch_scc0 L_ps1_re
    s_mov_b32 s93, 1
    s_branch L_ps1_fok
L_ps1_re:
    s_cmp_lg_u32 s77, 0
    s_cbranch_scc1 L_ps1_ld
    v_readfirstlane_b32 s77, v38
L_ps1_ld:
    v_mov_b32 v241, 128
    buffer_load_dword v38, v241, s[48:51], 0 offen sc1
    buffer_load_dwordx4 v[244:247], v240, s[44:47], s94 offen sc1
    buffer_load_dword v248, v242, s[44:47], s95 offen sc1
    s_branch L_ps1
L_ps1_fok:
L_ps1:
    s_waitcnt lgkmcnt(9)
    v_mfma_f32_32x32x16_bf16 v[44:59], v[76:79], v[92:95], v[44:59]
    ds_read_b64_tr_b16 v[76:77], v33 offset:0
    ds_read_b64_tr_b16 v[78:79], v33 offset:1024
    ds_read_b128 v[92:95], v24 offset:512
    s_waitcnt lgkmcnt(9)
    v_mfma_f32_32x32x16_bf16 v[44:59], v[80:83], v[96:99], v[44:59]
    ds_read_b64_tr_b16 v[80:81], v33 offset:4096
    ds_read_b64_tr_b16 v[82:83], v33 offset:5120
    ds_read_b128 v[96:99], v25 offset:512
    s_waitcnt lgkmcnt(9)
    v_mfma_f32_32x32x16_bf16 v[44:59], v[84:87], v[100:103], v[44:59]
    ds_read_b64_tr_b16 v[84:85], v33 offset:8192
    ds_read_b64_tr_b16 v[86:87], v33 offset:9216
    ds_read_b128 v[100:103], v26 offset:512
    s_waitcnt lgkmcnt(9)
    v_mfma_f32_32x32x16_bf16 v[44:59], v[88:91], v[104:107], v[44:59]
    ds_read_b64_tr_b16 v[88:89], v33 offset:12288
    ds_read_b64_tr_b16 v[90:91], v33 offset:13312
    ds_read_b128 v[104:107], v27 offset:512
    s_waitcnt lgkmcnt(9)
    v_mfma_f32_32x32x16_bf16 v[44:59], v[76:79], v[92:95], v[44:59]
    s_waitcnt lgkmcnt(6)
    v_mfma_f32_32x32x16_bf16 v[44:59], v[80:83], v[96:99], v[44:59]
    s_waitcnt lgkmcnt(3)
    v_mfma_f32_32x32x16_bf16 v[44:59], v[84:87], v[100:103], v[44:59]
    s_waitcnt lgkmcnt(0)
    s_cmp_eq_u32 s75, 1
    s_cbranch_scc1 L_q2_kv
    s_waitcnt vmcnt(0)
    s_barrier
    s_branch L_q2_j
L_q2_kv:
    s_barrier
L_q2_j:
    ds_read_b64_tr_b16 v[76:77], v28 offset:0
    ds_read_b64_tr_b16 v[78:79], v28 offset:1024
    ds_read_b128 v[92:95], v20 offset:768
    ds_read_b64_tr_b16 v[80:81], v28 offset:4096
    ds_read_b64_tr_b16 v[82:83], v28 offset:5120
    ds_read_b128 v[96:99], v21 offset:768
    ds_read_b64_tr_b16 v[84:85], v28 offset:8192
    ds_read_b64_tr_b16 v[86:87], v28 offset:9216
    ds_read_b128 v[100:103], v22 offset:768
    v_mfma_f32_32x32x16_bf16 v[44:59], v[88:91], v[104:107], v[44:59]
    ds_read_b64_tr_b16 v[88:89], v28 offset:12288
    ds_read_b64_tr_b16 v[90:91], v28 offset:13312
    ds_read_b128 v[104:107], v23 offset:768
    s_cmp_eq_u32 s92, 1
    s_cbranch_scc0 L_ps2
    s_cmp_eq_u32 s77, 0
    s_cbranch_scc1 L_xp2
    s_cmp_lg_u32 s99, 0
    s_cbranch_scc1 L_xp2
    s_or_b32 s99, s77, s97
    s_lshl_b32 s78, s67, 7
    s_lshl_b32 s79, s68, 2
    s_add_u32 s78, s78, s79
    s_add_u32 s78, s78, 548864
    v_mov_b32 v241, 0
    v_mov_b32 v249, s99
    buffer_store_dword v249, v241, s[44:47], s78 offen sc1
L_xp2:
    s_cmp_lg_u32 s93, 0
    s_cbranch_scc1 L_ps2_fok
    s_waitcnt vmcnt(0)
    s_cmp_eq_u32 s77, 0
    s_cbranch_scc1 L_ps2_re
    v_cmp_eq_u32 vcc, s77, v244
    v_cmp_eq_u32 s[80:81], s77, v245
    s_and_b64 vcc, vcc, s[80:81]
    v_cmp_eq_u32 s[80:81], s77, v246
    s_and_b64 vcc, vcc, s[80:81]
    v_cmp_eq_u32 s[80:81], s77, v247
    s_and_b64 vcc, vcc, s[80:81]
    v_cmp_eq_u32 s[80:81], s77, v248
    s_and_b64 vcc, vcc, s[80:81]
    s_cmp_eq_u64 vcc, exec
    s_cbranch_scc0 L_ps2_re
    s_mov_b32 s93, 1
    s_branch L_ps2_fok
L_ps2_re:
    s_cmp_lg_u32 s77, 0
    s_cbranch_scc1 L_ps2_ld
    v_readfirstlane_b32 s77, v38
L_ps2_ld:
    v_mov_b32 v241, 128
    buffer_load_dword v38, v241, s[48:51], 0 offen sc1
    buffer_load_dwordx4 v[244:247], v240, s[44:47], s94 offen sc1
    buffer_load_dword v248, v242, s[44:47], s95 offen sc1
    s_branch L_ps2
L_ps2_fok:
    s_cmp_eq_u32 s93, 1
    s_cbranch_scc0 L_ps2
    s_lshl_b32 s85, s65, 17
    s_mov_b32 s84, 32768
    s_mov_b32 m0, s84
    s_add_u32 s84, s84, 1024
    buffer_load_dwordx4 v2, s[44:47], s85 offen sc1 lds
    s_add_u32 s85, s85, 1024
    s_mov_b32 m0, s84
    s_add_u32 s84, s84, 1024
    buffer_load_dwordx4 v2, s[44:47], s85 offen sc1 lds
    s_add_u32 s85, s85, 1024
    s_mov_b32 m0, s84
    s_add_u32 s84, s84, 1024
    buffer_load_dwordx4 v2, s[44:47], s85 offen sc1 lds
    s_add_u32 s85, s85, 1024
    s_mov_b32 m0, s84
    s_add_u32 s84, s84, 1024
    buffer_load_dwordx4 v2, s[44:47], s85 offen sc1 lds
    s_add_u32 s85, s85, 1024
    s_mov_b32 m0, s84
    s_add_u32 s84, s84, 1024
    buffer_load_dwordx4 v2, s[44:47], s85 offen sc1 lds
    s_add_u32 s85, s85, 1024
    s_mov_b32 m0, s84
    s_add_u32 s84, s84, 1024
    buffer_load_dwordx4 v2, s[44:47], s85 offen sc1 lds
    s_add_u32 s85, s85, 1024
    s_mov_b32 m0, s84
    s_add_u32 s84, s84, 1024
    buffer_load_dwordx4 v2, s[44:47], s85 offen sc1 lds
    s_add_u32 s85, s85, 1024
    s_mov_b32 m0, s84
    s_add_u32 s84, s84, 1024
    buffer_load_dwordx4 v2, s[44:47], s85 offen sc1 lds
    s_add_u32 s85, s85, 1024
    s_mov_b32 s93, 2
L_ps2:
    s_cmp_eq_u32 s64, 0
    s_cbranch_scc0 L_nocz
    v_mov_b32 v200, 0
    ds_write_b32 v200, v200 offset:31744
L_nocz:
    s_waitcnt lgkmcnt(9)
    v_mfma_f32_32x32x16_bf16 v[44:59], v[76:79], v[92:95], v[44:59]
    ds_read_b64_tr_b16 v[76:77], v29 offset:0
    ds_read_b64_tr_b16 v[78:79], v29 offset:1024
    ds_read_b128 v[92:95], v24 offset:768
    s_waitcnt lgkmcnt(9)
    v_mfma_f32_32x32x16_bf16 v[44:59], v[80:83], v[96:99], v[44:59]
    ds_read_b64_tr_b16 v[80:81], v29 offset:4096
    ds_read_b64_tr_b16 v[82:83], v29 offset:5120
    ds_read_b128 v[96:99], v25 offset:768
    s_waitcnt lgkmcnt(9)
    v_mfma_f32_32x32x16_bf16 v[44:59], v[84:87], v[100:103], v[44:59]
    ds_read_b64_tr_b16 v[84:85], v29 offset:8192
    ds_read_b64_tr_b16 v[86:87], v29 offset:9216
    ds_read_b128 v[100:103], v26 offset:768
    s_waitcnt lgkmcnt(9)
    v_mfma_f32_32x32x16_bf16 v[44:59], v[88:91], v[104:107], v[44:59]
    ds_read_b64_tr_b16 v[88:89], v29 offset:12288
    ds_read_b64_tr_b16 v[90:91], v29 offset:13312
    ds_read_b128 v[104:107], v27 offset:768
    s_waitcnt lgkmcnt(9)
    v_mfma_f32_32x32x16_bf16 v[44:59], v[76:79], v[92:95], v[44:59]
    s_waitcnt lgkmcnt(6)
    v_mfma_f32_32x32x16_bf16 v[44:59], v[80:83], v[96:99], v[44:59]
    s_waitcnt lgkmcnt(3)
    v_mfma_f32_32x32x16_bf16 v[44:59], v[84:87], v[100:103], v[44:59]
    s_waitcnt lgkmcnt(0)
    v_mfma_f32_32x32x16_bf16 v[44:59], v[88:91], v[104:107], v[44:59]
    s_mov_b32 s78, 0x3eb8aa3b
    v_add_u32 v3, 33792, v3
    v_and_b32 v12, 27, v1
    v_cmp_eq_u32 vcc, 16, v12
    v_mov_b32 v13, 0x3f803f80
    v_add_u32 v133, 0x10000, v3
    v_cndmask_b32 v116, 0, v13, vcc
    v_cndmask_b32 v117, 0, v13, vcc
    v_cndmask_b32 v118, 0, v13, vcc
    v_cndmask_b32 v119, 0, v13, vcc
    v_cndmask_b32 v120, 0, v13, vcc
    v_cndmask_b32 v121, 0, v13, vcc
    v_cndmask_b32 v122, 0, v13, vcc
    v_cndmask_b32 v123, 0, v13, vcc
    v_cndmask_b32 v124, 0, v13, vcc
    v_cndmask_b32 v125, 0, v13, vcc
    v_cndmask_b32 v126, 0, v13, vcc
    v_cndmask_b32 v127, 0, v13, vcc
    v_cndmask_b32 v128, 0, v13, vcc
    v_cndmask_b32 v129, 0, v13, vcc
    v_cndmask_b32 v130, 0, v13, vcc
    v_cndmask_b32 v131, 0, v13, vcc
    s_mov_b32 s79, s78
    v_pk_mul_f32 v[44:45], v[44:45], s[78:79]
    v_pk_mul_f32 v[46:47], v[46:47], s[78:79]
    v_pk_mul_f32 v[48:49], v[48:49], s[78:79]
    v_pk_mul_f32 v[50:51], v[50:51], s[78:79]
    v_pk_mul_f32 v[52:53], v[52:53], s[78:79]
    v_pk_mul_f32 v[54:55], v[54:55], s[78:79]
    v_pk_mul_f32 v[56:57], v[56:57], s[78:79]
    v_pk_mul_f32 v[58:59], v[58:59], s[78:79]
    v_cvt_pk_bf16_f32 v4, v44, v45
    v_cvt_pk_bf16_f32 v8, v52, v53
    v_cvt_pk_bf16_f32 v5, v46, v47
    v_cvt_pk_bf16_f32 v9, v54, v55
    v_cvt_pk_bf16_f32 v6, v48, v49
    v_cvt_pk_bf16_f32 v10, v56, v57
    v_cvt_pk_bf16_f32 v7, v50, v51
    v_cvt_pk_bf16_f32 v11, v58, v59
    s_cmp_eq_u32 s92, 1
    s_cbranch_scc0 L_nopoll
    s_cmp_eq_u32 s93, 2
    s_cbranch_scc1 L_nopoll
    s_cmp_eq_u32 s93, 1
    s_cbranch_scc1 L_dofirst
    s_waitcnt vmcnt(0)
    s_cmp_lg_u32 s77, 0
    s_cbranch_scc0 L_getnonce
    v_cmp_eq_u32 vcc, s77, v244
    v_cmp_eq_u32 s[80:81], s77, v245
    s_and_b64 vcc, vcc, s[80:81]
    v_cmp_eq_u32 s[80:81], s77, v246
    s_and_b64 vcc, vcc, s[80:81]
    v_cmp_eq_u32 s[80:81], s77, v247
    s_and_b64 vcc, vcc, s[80:81]
    v_cmp_eq_u32 s[80:81], s77, v248
    s_and_b64 vcc, vcc, s[80:81]
    s_cmp_eq_u64 vcc, exec
    s_cbranch_scc1 L_dofirst
    s_branch L_havenonce
L_getnonce:
    v_readfirstlane_b32 s77, v38
    v_mov_b32 v241, 128
    s_cmp_lg_u32 s77, 0
    s_cbranch_scc1 L_havenonce
    s_mov_b32 s79, 0
L_polln:
    buffer_load_dword v38, v241, s[48:51], 0 offen sc1
    s_waitcnt vmcnt(0)
    v_cmp_ne_u32 vcc, 0, v38
    s_cmp_eq_u64 vcc, exec
    s_cbranch_scc1 L_polln_done
    s_add_u32 s79, s79, 1
    s_cmp_lt_u32 s79, 8192
    s_cbranch_scc0 L_polln_done
    s_sleep 1
    s_branch L_polln
L_polln_done:
    v_readfirstlane_b32 s77, v38
L_havenonce:
    s_mov_b32 s79, 0
L_poll:
    buffer_load_dwordx4 v[244:247], v240, s[44:47], s94 offen sc1
    buffer_load_dword v248, v242, s[44:47], s95 offen sc1
    s_waitcnt vmcnt(0)
    v_cmp_eq_u32 vcc, s77, v244
    v_cmp_eq_u32 s[80:81], s77, v245
    s_and_b64 vcc, vcc, s[80:81]
    v_cmp_eq_u32 s[80:81], s77, v246
    s_and_b64 vcc, vcc, s[80:81]
    v_cmp_eq_u32 s[80:81], s77, v247
    s_and_b64 vcc, vcc, s[80:81]
    v_cmp_eq_u32 s[80:81], s77, v248
    s_and_b64 vcc, vcc, s[80:81]
    s_cmp_eq_u64 vcc, exec
    s_cbranch_scc1 L_poll_done
    s_add_u32 s79, s79, 1
    s_cmp_lt_u32 s79, 8192
    s_cbranch_scc0 L_poll_done
    s_sleep 1
    s_branch L_poll
L_poll_done:
L_dofirst:
    s_lshl_b32 s85, s65, 17
    s_mov_b32 s84, 32768
    s_mov_b32 m0, s84
    s_add_u32 s84, s84, 1024
    buffer_load_dwordx4 v2, s[44:47], s85 offen sc1 lds
    s_add_u32 s85, s85, 1024
    s_mov_b32 m0, s84
    s_add_u32 s84, s84, 1024
    buffer_load_dwordx4 v2, s[44:47], s85 offen sc1 lds
    s_add_u32 s85, s85, 1024
    s_mov_b32 m0, s84
    s_add_u32 s84, s84, 1024
    buffer_load_dwordx4 v2, s[44:47], s85 offen sc1 lds
    s_add_u32 s85, s85, 1024
    s_mov_b32 m0, s84
    s_add_u32 s84, s84, 1024
    buffer_load_dwordx4 v2, s[44:47], s85 offen sc1 lds
    s_add_u32 s85, s85, 1024
    s_mov_b32 m0, s84
    s_add_u32 s84, s84, 1024
    buffer_load_dwordx4 v2, s[44:47], s85 offen sc1 lds
    s_add_u32 s85, s85, 1024
    s_mov_b32 m0, s84
    s_add_u32 s84, s84, 1024
    buffer_load_dwordx4 v2, s[44:47], s85 offen sc1 lds
    s_add_u32 s85, s85, 1024
    s_mov_b32 m0, s84
    s_add_u32 s84, s84, 1024
    buffer_load_dwordx4 v2, s[44:47], s85 offen sc1 lds
    s_add_u32 s85, s85, 1024
    s_mov_b32 m0, s84
    s_add_u32 s84, s84, 1024
    buffer_load_dwordx4 v2, s[44:47], s85 offen sc1 lds
    s_add_u32 s85, s85, 1024
    s_mov_b32 s93, 2
L_nopoll:
    s_cmp_eq_u32 s92, 1
    s_cbranch_scc0 L_noxp
    s_cmp_eq_u32 s77, 0
    s_cbranch_scc1 L_xp9
    s_cmp_lg_u32 s99, 0
    s_cbranch_scc1 L_xp9
    s_or_b32 s99, s77, s97
    s_lshl_b32 s78, s67, 7
    s_lshl_b32 s79, s68, 2
    s_add_u32 s78, s78, s79
    s_add_u32 s78, s78, 548864
    v_mov_b32 v241, 0
    v_mov_b32 v249, s99
    buffer_store_dword v249, v241, s[44:47], s78 offen sc1
L_xp9:
L_noxp:
    v_pk_mov_b32 v[76:77], 0, 0
    v_pk_mov_b32 v[92:93], 0, 0
    v_pk_mov_b32 v[78:79], 0, 0
    v_pk_mov_b32 v[94:95], 0, 0
    v_pk_mov_b32 v[80:81], 0, 0
    v_pk_mov_b32 v[96:97], 0, 0
    v_pk_mov_b32 v[82:83], 0, 0
    v_pk_mov_b32 v[98:99], 0, 0
    v_pk_mov_b32 v[84:85], 0, 0
    v_pk_mov_b32 v[100:101], 0, 0
    v_pk_mov_b32 v[86:87], 0, 0
    v_pk_mov_b32 v[102:103], 0, 0
    v_pk_mov_b32 v[88:89], 0, 0
    v_pk_mov_b32 v[104:105], 0, 0
    v_pk_mov_b32 v[90:91], 0, 0
    v_pk_mov_b32 v[106:107], 0, 0
    v_lshrrev_b32 v12, 2, v1
    v_and_b32 v13, 3, v1
    v_lshlrev_b32 v13, 4, v13
    v_lshl_add_u32 v134, v12, 10, v13
    s_lshr_b32 s78, s68, 1
    s_lshl_b32 s78, s78, 8
    s_lshl_b32 s79, s70, 6
    s_add_u32 s78, s78, s79
    v_add_u32 v134, s78, v134
    v_lshrrev_b32 v13, 2, v17
    v_lshl_add_u32 v13, v16, 2, v13
    v_lshlrev_b32 v135, 6, v13
    v_bfe_u32 v13, v1, 4, 1
    v_lshl_add_u32 v135, v13, 5, v135
    v_and_b32 v12, 3, v17
    v_lshl_add_u32 v135, v12, 3, v135
    s_lshl_b32 s78, s64, 12
    v_add_u32 v135, s78, v135
    v_mov_b32 v0, 0xdddddddd
    s_lshl_b32 s85, s65, 17
    s_add_u32 s85, s85, 8192
    s_lshl_b32 s84, s70, 11
    s_add_u32 s85, s85, s84
    s_add_u32 s84, s84, 40960
    v_mov_b32 v253, v2
    v_add_u32 v2, 32768, v2
    v_add_u32 v132, 0x10000, v2
    s_mov_b32 s74, 1
    s_lshr_b32 s96, s64, 2
    v_and_b32 v252, 31, v1
    v_lshlrev_b32 v252, 2, v252
    s_lshl_b32 s80, s67, 1
    s_add_u32 s80, s80, s69
    s_lshl_b32 s80, s80, 7
    s_add_u32 s80, s80, 262144
    s_waitcnt vmcnt(0)
    s_barrier
    buffer_load_dword v252, v252, s[44:47], s80 offen sc1
    ds_read_b128 v[108:111], v2 offset:0
    ds_read_b128 v[112:115], v2 offset:2048
    s_mov_b64 exec, s[72:73]
    ds_read_b128 v[116:119], v3 offset:0
    ds_read_b128 v[124:127], v3 offset:512
    s_mov_b64 exec, -1
    s_waitcnt lgkmcnt(3)
    v_mfma_f32_32x32x16_bf16 v[44:59], v[108:111], v[4:7], 0
    v_mfma_f32_32x32x16_bf16 v[60:75], v[108:111], v[8:11], 0
    s_nop 10
    v_max3_f32 v136, v44, v45, v46
    v_max3_f32 v136, v136, v47, v48
    v_max3_f32 v136, v136, v49, v50
    v_max3_f32 v136, v136, v51, v52
    v_max3_f32 v136, v136, v53, v54
    v_max3_f32 v136, v136, v55, v56
    v_max3_f32 v136, v136, v57, v58
    v_max_f32 v136, v136, v59
    v_max3_f32 v138, v60, v61, v62
    v_max3_f32 v138, v138, v63, v64
    v_max3_f32 v138, v138, v65, v66
    v_max3_f32 v138, v138, v67, v68
    v_max3_f32 v138, v138, v69, v70
    v_max3_f32 v138, v138, v71, v72
    v_max3_f32 v138, v138, v73, v74
    v_max_f32 v138, v138, v75
    v_mov_b32 v137, v136
    s_nop 1
    v_permlane32_swap_b32 v136, v137
    s_nop 1
    v_max_f32 v136, v136, v137
    v_mov_b32 v139, v138
    s_nop 1
    v_permlane32_swap_b32 v138, v139
    s_nop 1
    v_max_f32 v138, v138, v139
    v_pk_mul_f32 v[12:13], v[136:137], -1.0 op_sel_hi:[0,0]
    v_pk_mul_f32 v[14:15], v[136:137], -1.0 op_sel_hi:[0,0]
    v_pk_mul_f32 v[16:17], v[136:137], -1.0 op_sel_hi:[0,0]
    v_pk_mul_f32 v[18:19], v[136:137], -1.0 op_sel_hi:[0,0]
    v_pk_mul_f32 v[20:21], v[136:137], -1.0 op_sel_hi:[0,0]
    v_pk_mul_f32 v[22:23], v[136:137], -1.0 op_sel_hi:[0,0]
    v_pk_mul_f32 v[24:25], v[136:137], -1.0 op_sel_hi:[0,0]
    v_pk_mul_f32 v[26:27], v[136:137], -1.0 op_sel_hi:[0,0]
    v_pk_mul_f32 v[28:29], v[138:139], -1.0 op_sel_hi:[0,0]
    v_pk_mul_f32 v[30:31], v[138:139], -1.0 op_sel_hi:[0,0]
    v_pk_mul_f32 v[32:33], v[138:139], -1.0 op_sel_hi:[0,0]
    v_pk_mul_f32 v[34:35], v[138:139], -1.0 op_sel_hi:[0,0]
    v_pk_mul_f32 v[36:37], v[138:139], -1.0 op_sel_hi:[0,0]
    v_pk_mul_f32 v[38:39], v[138:139], -1.0 op_sel_hi:[0,0]
    v_pk_mul_f32 v[40:41], v[138:139], -1.0 op_sel_hi:[0,0]
    v_pk_mul_f32 v[42:43], v[138:139], -1.0 op_sel_hi:[0,0]
    s_branch L_go
L_restart:
    v_pk_mov_b32 v[76:77], 0, 0
    v_pk_mov_b32 v[92:93], 0, 0
    v_pk_mov_b32 v[78:79], 0, 0
    v_pk_mov_b32 v[94:95], 0, 0
    v_pk_mov_b32 v[80:81], 0, 0
    v_pk_mov_b32 v[96:97], 0, 0
    v_pk_mov_b32 v[82:83], 0, 0
    v_pk_mov_b32 v[98:99], 0, 0
    v_pk_mov_b32 v[84:85], 0, 0
    v_pk_mov_b32 v[100:101], 0, 0
    v_pk_mov_b32 v[86:87], 0, 0
    v_pk_mov_b32 v[102:103], 0, 0
    v_pk_mov_b32 v[88:89], 0, 0
    v_pk_mov_b32 v[104:105], 0, 0
    v_pk_mov_b32 v[90:91], 0, 0
    v_pk_mov_b32 v[106:107], 0, 0
    ds_read_b128 v[108:111], v2 offset:0
    ds_read_b128 v[112:115], v2 offset:2048
    s_mov_b64 exec, s[72:73]
    ds_read_b128 v[116:119], v3 offset:0
    ds_read_b128 v[124:127], v3 offset:512
    s_mov_b64 exec, -1
L_go:
    v_pk_mov_b32 v[68:69], 0, 0
    v_pk_mov_b32 v[70:71], 0, 0
    v_pk_mov_b32 v[72:73], 0, 0
    v_pk_mov_b32 v[74:75], 0, 0
    s_waitcnt lgkmcnt(0)
    v_mfma_f32_32x32x16_bf16 v[44:59], v[108:111], v[4:7], v[12:27]
    s_cmp_ge_u32 s64, 4
    s_cbranch_scc0 L_noprio0
    s_setprio 1
L_noprio0:
    s_nop 7
    s_nop 1
    v_exp_f32 v44, v44
    v_exp_f32 v45, v45
    v_smfmac_f32_32x32x32_bf16 v[92:107], v[128:131], v[68:75], v0
    v_exp_f32 v46, v46
    v_exp_f32 v47, v47
    v_exp_f32 v48, v48
    v_mfma_f32_32x32x16_bf16 v[60:75], v[108:111], v[8:11], v[28:43]
    ds_read_b128 v[108:111], v2 offset:4096
    s_mov_b64 exec, s[72:73]
    ds_read_b128 v[120:123], v3 offset:2048
    ds_read_b128 v[128:131], v3 offset:2560
    s_mov_b64 exec, -1
    v_exp_f32 v49, v49
    v_exp_f32 v50, v50
    v_exp_f32 v51, v51
    v_exp_f32 v52, v52
    v_exp_f32 v53, v53
    s_waitcnt lgkmcnt(3)
    v_smfmac_f32_32x32x32_bf16 v[76:91], v[116:119], v[44:51], v0
    v_exp_f32 v54, v54
    v_exp_f32 v55, v55
    v_exp_f32 v56, v56
    s_cmp_eq_u32 s96, 1
    s_cbranch_scc0 L_nokv0
    s_mov_b32 m0, s84
    s_add_u32 s78, s85, 1024
    buffer_load_dwordx4 v253, s[44:47], s85 offen sc1 lds
    s_add_u32 m0, s84, 1024
    s_add_u32 s84, s84, 8192
    buffer_load_dwordx4 v253, s[44:47], s78 offen sc1 lds
    s_add_u32 s85, s85, 8192
L_nokv0:
    v_exp_f32 v57, v57
    v_exp_f32 v58, v58
    v_exp_f32 v59, v59
    v_exp_f32 v60, v60
    v_exp_f32 v61, v61
    v_smfmac_f32_32x32x32_bf16 v[76:91], v[124:127], v[52:59], v0
    v_exp_f32 v62, v62
    v_exp_f32 v63, v63
    v_exp_f32 v64, v64
    v_mfma_f32_32x32x16_bf16 v[44:59], v[112:115], v[4:7], v[12:27]
    v_exp_f32 v65, v65
    v_exp_f32 v66, v66
    v_exp_f32 v67, v67
    v_exp_f32 v68, v68
    v_exp_f32 v69, v69
    v_smfmac_f32_32x32x32_bf16 v[92:107], v[116:119], v[60:67], v0
    v_exp_f32 v70, v70
    v_exp_f32 v71, v71
    v_exp_f32 v72, v72
    v_exp_f32 v73, v73
    v_exp_f32 v74, v74
    v_exp_f32 v75, v75
    v_exp_f32 v44, v44
    v_exp_f32 v45, v45
    v_smfmac_f32_32x32x32_bf16 v[92:107], v[124:127], v[68:75], v0
    v_exp_f32 v46, v46
    v_exp_f32 v47, v47
    v_exp_f32 v48, v48
    v_mfma_f32_32x32x16_bf16 v[60:75], v[112:115], v[8:11], v[28:43]
    ds_read_b128 v[112:115], v2 offset:6144
    s_mov_b64 exec, s[72:73]
    ds_read_b128 v[116:119], v3 offset:4096
    ds_read_b128 v[124:127], v3 offset:4608
    s_mov_b64 exec, -1
    v_exp_f32 v49, v49
    v_exp_f32 v50, v50
    v_exp_f32 v51, v51
    v_exp_f32 v52, v52
    v_exp_f32 v53, v53
    s_waitcnt lgkmcnt(3)
    v_smfmac_f32_32x32x32_bf16 v[76:91], v[120:123], v[44:51], v0
    v_exp_f32 v54, v54
    v_exp_f32 v55, v55
    v_exp_f32 v56, v56
    s_cmp_eq_u32 s96, 1
    s_cbranch_scc0 L_nokv1
    s_mov_b32 m0, s84
    s_add_u32 s78, s85, 1024
    buffer_load_dwordx4 v253, s[44:47], s85 offen sc1 lds
    s_add_u32 m0, s84, 1024
    s_add_u32 s84, s84, 8192
    buffer_load_dwordx4 v253, s[44:47], s78 offen sc1 lds
    s_add_u32 s85, s85, 8192
L_nokv1:
    v_exp_f32 v57, v57
    v_exp_f32 v58, v58
    v_exp_f32 v59, v59
    v_exp_f32 v60, v60
    v_exp_f32 v61, v61
    v_smfmac_f32_32x32x32_bf16 v[76:91], v[128:131], v[52:59], v0
    v_exp_f32 v62, v62
    v_exp_f32 v63, v63
    v_exp_f32 v64, v64
    v_mfma_f32_32x32x16_bf16 v[44:59], v[108:111], v[4:7], v[12:27]
    v_exp_f32 v65, v65
    v_exp_f32 v66, v66
    v_exp_f32 v67, v67
    v_exp_f32 v68, v68
    v_exp_f32 v69, v69
    v_smfmac_f32_32x32x32_bf16 v[92:107], v[120:123], v[60:67], v0
    v_exp_f32 v70, v70
    v_exp_f32 v71, v71
    v_exp_f32 v72, v72
    v_exp_f32 v73, v73
    v_exp_f32 v74, v74
    v_exp_f32 v75, v75
    s_cmp_eq_u32 s74, 1
    s_cbranch_scc0 L_sy1_done
    s_cmp_ge_u32 s64, 4
    s_cbranch_scc0 L_sy1_spin
    s_waitcnt vmcnt(2)
    v_mov_b32 v254, 1
    s_mov_b64 exec, 1
    ds_add_u32 v253, v254 offset:31744
    s_mov_b64 exec, -1
L_sy1_spin:
    ds_read_b32 v254, v253 offset:31744
    s_waitcnt lgkmcnt(0)
    v_readfirstlane_b32 s78, v254
    s_cmp_ge_u32 s78, 4
    s_cbranch_scc0 L_sy1_spin
L_sy1_done:
    v_exp_f32 v44, v44
    v_exp_f32 v45, v45
    v_smfmac_f32_32x32x32_bf16 v[92:107], v[128:131], v[68:75], v0
    v_exp_f32 v46, v46
    v_exp_f32 v47, v47
    v_exp_f32 v48, v48
    v_mfma_f32_32x32x16_bf16 v[60:75], v[108:111], v[8:11], v[28:43]
    ds_read_b128 v[108:111], v2 offset:8192
    s_mov_b64 exec, s[72:73]
    ds_read_b128 v[120:123], v3 offset:6144
    ds_read_b128 v[128:131], v3 offset:6656
    s_mov_b64 exec, -1
    v_exp_f32 v49, v49
    v_exp_f32 v50, v50
    v_exp_f32 v51, v51
    v_exp_f32 v52, v52
    v_exp_f32 v53, v53
    s_waitcnt lgkmcnt(3)
    v_smfmac_f32_32x32x32_bf16 v[76:91], v[116:119], v[44:51], v0
    v_exp_f32 v54, v54
    v_exp_f32 v55, v55
    v_exp_f32 v56, v56
    s_cmp_eq_u32 s96, 1
    s_cbranch_scc0 L_nokv2
    s_mov_b32 m0, s84
    s_add_u32 s78, s85, 1024
    buffer_load_dwordx4 v253, s[44:47], s85 offen sc1 lds
    s_add_u32 m0, s84, 1024
    s_add_u32 s84, s84, 8192
    buffer_load_dwordx4 v253, s[44:47], s78 offen sc1 lds
    s_add_u32 s85, s85, 8192
L_nokv2:
    v_exp_f32 v57, v57
    v_exp_f32 v58, v58
    v_exp_f32 v59, v59
    v_exp_f32 v60, v60
    v_exp_f32 v61, v61
    v_smfmac_f32_32x32x32_bf16 v[76:91], v[124:127], v[52:59], v0
    v_exp_f32 v62, v62
    v_exp_f32 v63, v63
    v_exp_f32 v64, v64
    v_mfma_f32_32x32x16_bf16 v[44:59], v[112:115], v[4:7], v[12:27]
    v_exp_f32 v65, v65
    v_exp_f32 v66, v66
    v_exp_f32 v67, v67
    v_exp_f32 v68, v68
    v_exp_f32 v69, v69
    v_smfmac_f32_32x32x32_bf16 v[92:107], v[116:119], v[60:67], v0
    v_exp_f32 v70, v70
    v_exp_f32 v71, v71
    v_exp_f32 v72, v72
    v_exp_f32 v73, v73
    v_exp_f32 v74, v74
    v_exp_f32 v75, v75
    v_exp_f32 v44, v44
    v_exp_f32 v45, v45
    v_smfmac_f32_32x32x32_bf16 v[92:107], v[124:127], v[68:75], v0
    v_exp_f32 v46, v46
    v_exp_f32 v47, v47
    v_exp_f32 v48, v48
    v_mfma_f32_32x32x16_bf16 v[60:75], v[112:115], v[8:11], v[28:43]
    ds_read_b128 v[112:115], v2 offset:10240
    s_mov_b64 exec, s[72:73]
    ds_read_b128 v[116:119], v3 offset:8192
    ds_read_b128 v[124:127], v3 offset:8704
    s_mov_b64 exec, -1
    v_exp_f32 v49, v49
    v_exp_f32 v50, v50
    v_exp_f32 v51, v51
    v_exp_f32 v52, v52
    v_exp_f32 v53, v53
    s_waitcnt lgkmcnt(3)
    v_smfmac_f32_32x32x32_bf16 v[76:91], v[120:123], v[44:51], v0
    v_exp_f32 v54, v54
    v_exp_f32 v55, v55
    v_exp_f32 v56, v56
    s_cmp_eq_u32 s96, 1
    s_cbranch_scc0 L_nokv3
    s_mov_b32 m0, s84
    s_add_u32 s78, s85, 1024
    buffer_load_dwordx4 v253, s[44:47], s85 offen sc1 lds
    s_add_u32 m0, s84, 1024
    s_add_u32 s84, s84, 8192
    buffer_load_dwordx4 v253, s[44:47], s78 offen sc1 lds
    s_add_u32 s85, s85, 8192
L_nokv3:
    v_exp_f32 v57, v57
    v_exp_f32 v58, v58
    v_exp_f32 v59, v59
    v_exp_f32 v60, v60
    v_exp_f32 v61, v61
    v_smfmac_f32_32x32x32_bf16 v[76:91], v[128:131], v[52:59], v0
    v_exp_f32 v62, v62
    v_exp_f32 v63, v63
    v_exp_f32 v64, v64
    v_mfma_f32_32x32x16_bf16 v[44:59], v[108:111], v[4:7], v[12:27]
    v_exp_f32 v65, v65
    v_exp_f32 v66, v66
    v_exp_f32 v67, v67
    v_exp_f32 v68, v68
    v_exp_f32 v69, v69
    v_smfmac_f32_32x32x32_bf16 v[92:107], v[120:123], v[60:67], v0
    v_exp_f32 v70, v70
    v_exp_f32 v71, v71
    v_exp_f32 v72, v72
    v_exp_f32 v73, v73
    v_exp_f32 v74, v74
    v_exp_f32 v75, v75
    v_exp_f32 v44, v44
    v_exp_f32 v45, v45
    v_smfmac_f32_32x32x32_bf16 v[92:107], v[128:131], v[68:75], v0
    v_exp_f32 v46, v46
    v_exp_f32 v47, v47
    v_exp_f32 v48, v48
    v_mfma_f32_32x32x16_bf16 v[60:75], v[108:111], v[8:11], v[28:43]
    ds_read_b128 v[108:111], v2 offset:12288
    s_mov_b64 exec, s[72:73]
    ds_read_b128 v[120:123], v3 offset:10240
    ds_read_b128 v[128:131], v3 offset:10752
    s_mov_b64 exec, -1
    v_exp_f32 v49, v49
    v_exp_f32 v50, v50
    v_exp_f32 v51, v51
    v_exp_f32 v52, v52
    v_exp_f32 v53, v53
    s_waitcnt lgkmcnt(3)
    v_smfmac_f32_32x32x32_bf16 v[76:91], v[116:119], v[44:51], v0
    v_exp_f32 v54, v54
    v_exp_f32 v55, v55
    v_exp_f32 v56, v56
    s_cmp_eq_u32 s96, 1
    s_cbranch_scc0 L_nokv4
    s_mov_b32 m0, s84
    s_add_u32 s78, s85, 1024
    buffer_load_dwordx4 v253, s[44:47], s85 offen sc1 lds
    s_add_u32 m0, s84, 1024
    s_add_u32 s84, s84, 8192
    buffer_load_dwordx4 v253, s[44:47], s78 offen sc1 lds
    s_add_u32 s85, s85, 8192
L_nokv4:
    v_exp_f32 v57, v57
    v_exp_f32 v58, v58
    v_exp_f32 v59, v59
    v_exp_f32 v60, v60
    v_exp_f32 v61, v61
    v_smfmac_f32_32x32x32_bf16 v[76:91], v[124:127], v[52:59], v0
    v_exp_f32 v62, v62
    v_exp_f32 v63, v63
    v_exp_f32 v64, v64
    v_mfma_f32_32x32x16_bf16 v[44:59], v[112:115], v[4:7], v[12:27]
    v_exp_f32 v65, v65
    v_exp_f32 v66, v66
    v_exp_f32 v67, v67
    v_exp_f32 v68, v68
    v_exp_f32 v69, v69
    v_smfmac_f32_32x32x32_bf16 v[92:107], v[116:119], v[60:67], v0
    v_exp_f32 v70, v70
    v_exp_f32 v71, v71
    v_exp_f32 v72, v72
    v_exp_f32 v73, v73
    v_exp_f32 v74, v74
    v_exp_f32 v75, v75
    v_exp_f32 v44, v44
    v_exp_f32 v45, v45
    v_smfmac_f32_32x32x32_bf16 v[92:107], v[124:127], v[68:75], v0
    v_exp_f32 v46, v46
    v_exp_f32 v47, v47
    v_exp_f32 v48, v48
    v_mfma_f32_32x32x16_bf16 v[60:75], v[112:115], v[8:11], v[28:43]
    ds_read_b128 v[112:115], v2 offset:14336
    s_mov_b64 exec, s[72:73]
    ds_read_b128 v[116:119], v3 offset:12288
    ds_read_b128 v[124:127], v3 offset:12800
    s_mov_b64 exec, -1
    v_exp_f32 v49, v49
    v_exp_f32 v50, v50
    v_exp_f32 v51, v51
    v_exp_f32 v52, v52
    v_exp_f32 v53, v53
    s_waitcnt lgkmcnt(3)
    v_smfmac_f32_32x32x32_bf16 v[76:91], v[120:123], v[44:51], v0
    v_exp_f32 v54, v54
    v_exp_f32 v55, v55
    v_exp_f32 v56, v56
    s_cmp_eq_u32 s96, 1
    s_cbranch_scc0 L_nokv5
    s_mov_b32 m0, s84
    s_add_u32 s78, s85, 1024
    buffer_load_dwordx4 v253, s[44:47], s85 offen sc1 lds
    s_add_u32 m0, s84, 1024
    s_add_u32 s84, s84, 8192
    buffer_load_dwordx4 v253, s[44:47], s78 offen sc1 lds
    s_add_u32 s85, s85, 8192
L_nokv5:
    v_exp_f32 v57, v57
    v_exp_f32 v58, v58
    v_exp_f32 v59, v59
    v_exp_f32 v60, v60
    v_exp_f32 v61, v61
    v_smfmac_f32_32x32x32_bf16 v[76:91], v[128:131], v[52:59], v0
    v_exp_f32 v62, v62
    v_exp_f32 v63, v63
    v_exp_f32 v64, v64
    v_mfma_f32_32x32x16_bf16 v[44:59], v[108:111], v[4:7], v[12:27]
    v_exp_f32 v65, v65
    v_exp_f32 v66, v66
    v_exp_f32 v67, v67
    v_exp_f32 v68, v68
    v_exp_f32 v69, v69
    v_smfmac_f32_32x32x32_bf16 v[92:107], v[120:123], v[60:67], v0
    v_exp_f32 v70, v70
    v_exp_f32 v71, v71
    v_exp_f32 v72, v72
    v_exp_f32 v73, v73
    v_exp_f32 v74, v74
    v_exp_f32 v75, v75
    s_cmp_eq_u32 s74, 1
    s_cbranch_scc0 L_sy2_done
    s_cmp_ge_u32 s64, 4
    s_cbranch_scc0 L_sy2_spin
    s_waitcnt vmcnt(6)
    v_mov_b32 v254, 1
    s_mov_b64 exec, 1
    ds_add_u32 v253, v254 offset:31744
    s_mov_b64 exec, -1
L_sy2_spin:
    ds_read_b32 v254, v253 offset:31744
    s_waitcnt lgkmcnt(0)
    v_readfirstlane_b32 s78, v254
    s_cmp_ge_u32 s78, 8
    s_cbranch_scc0 L_sy2_spin
L_sy2_done:
    v_exp_f32 v44, v44
    v_exp_f32 v45, v45
    v_smfmac_f32_32x32x32_bf16 v[92:107], v[128:131], v[68:75], v0
    v_exp_f32 v46, v46
    v_exp_f32 v47, v47
    v_exp_f32 v48, v48
    v_mfma_f32_32x32x16_bf16 v[60:75], v[108:111], v[8:11], v[28:43]
    ds_read_b128 v[108:111], v2 offset:16384
    s_mov_b64 exec, s[72:73]
    ds_read_b128 v[120:123], v3 offset:14336
    ds_read_b128 v[128:131], v3 offset:14848
    s_mov_b64 exec, -1
    v_exp_f32 v49, v49
    v_exp_f32 v50, v50
    v_exp_f32 v51, v51
    v_exp_f32 v52, v52
    v_exp_f32 v53, v53
    s_waitcnt lgkmcnt(3)
    v_smfmac_f32_32x32x32_bf16 v[76:91], v[116:119], v[44:51], v0
    v_exp_f32 v54, v54
    v_exp_f32 v55, v55
    v_exp_f32 v56, v56
    s_cmp_eq_u32 s96, 1
    s_cbranch_scc0 L_nokv6
    s_mov_b32 m0, s84
    s_add_u32 s78, s85, 1024
    buffer_load_dwordx4 v253, s[44:47], s85 offen sc1 lds
    s_add_u32 m0, s84, 1024
    s_add_u32 s84, s84, 8192
    buffer_load_dwordx4 v253, s[44:47], s78 offen sc1 lds
    s_add_u32 s85, s85, 8192
L_nokv6:
    v_exp_f32 v57, v57
    v_exp_f32 v58, v58
    v_exp_f32 v59, v59
    v_exp_f32 v60, v60
    v_exp_f32 v61, v61
    v_smfmac_f32_32x32x32_bf16 v[76:91], v[124:127], v[52:59], v0
    v_exp_f32 v62, v62
    v_exp_f32 v63, v63
    v_exp_f32 v64, v64
    v_mfma_f32_32x32x16_bf16 v[44:59], v[112:115], v[4:7], v[12:27]
    v_exp_f32 v65, v65
    v_exp_f32 v66, v66
    v_exp_f32 v67, v67
    v_exp_f32 v68, v68
    v_exp_f32 v69, v69
    v_smfmac_f32_32x32x32_bf16 v[92:107], v[116:119], v[60:67], v0
    v_exp_f32 v70, v70
    v_exp_f32 v71, v71
    v_exp_f32 v72, v72
    v_exp_f32 v73, v73
    v_exp_f32 v74, v74
    v_exp_f32 v75, v75
    v_exp_f32 v44, v44
    v_exp_f32 v45, v45
    v_smfmac_f32_32x32x32_bf16 v[92:107], v[124:127], v[68:75], v0
    v_exp_f32 v46, v46
    v_exp_f32 v47, v47
    v_exp_f32 v48, v48
    v_mfma_f32_32x32x16_bf16 v[60:75], v[112:115], v[8:11], v[28:43]
    ds_read_b128 v[112:115], v2 offset:18432
    s_mov_b64 exec, s[72:73]
    ds_read_b128 v[116:119], v3 offset:16384
    ds_read_b128 v[124:127], v3 offset:16896
    s_mov_b64 exec, -1
    v_exp_f32 v49, v49
    v_exp_f32 v50, v50
    v_exp_f32 v51, v51
    v_exp_f32 v52, v52
    v_exp_f32 v53, v53
    s_waitcnt lgkmcnt(3)
    v_smfmac_f32_32x32x32_bf16 v[76:91], v[120:123], v[44:51], v0
    v_exp_f32 v54, v54
    v_exp_f32 v55, v55
    v_exp_f32 v56, v56
    s_cmp_eq_u32 s96, 1
    s_cbranch_scc0 L_nokv7
    s_mov_b32 m0, s84
    s_add_u32 s78, s85, 1024
    buffer_load_dwordx4 v253, s[44:47], s85 offen sc1 lds
    s_add_u32 m0, s84, 1024
    s_add_u32 s84, s84, 8192
    buffer_load_dwordx4 v253, s[44:47], s78 offen sc1 lds
    s_add_u32 s85, s85, 8192
L_nokv7:
    v_exp_f32 v57, v57
    v_exp_f32 v58, v58
    v_exp_f32 v59, v59
    v_exp_f32 v60, v60
    v_exp_f32 v61, v61
    v_smfmac_f32_32x32x32_bf16 v[76:91], v[128:131], v[52:59], v0
    v_exp_f32 v62, v62
    v_exp_f32 v63, v63
    v_exp_f32 v64, v64
    v_mfma_f32_32x32x16_bf16 v[44:59], v[108:111], v[4:7], v[12:27]
    v_exp_f32 v65, v65
    v_exp_f32 v66, v66
    v_exp_f32 v67, v67
    v_exp_f32 v68, v68
    v_exp_f32 v69, v69
    v_smfmac_f32_32x32x32_bf16 v[92:107], v[120:123], v[60:67], v0
    v_exp_f32 v70, v70
    v_exp_f32 v71, v71
    v_exp_f32 v72, v72
    v_exp_f32 v73, v73
    v_exp_f32 v74, v74
    v_exp_f32 v75, v75
    v_exp_f32 v44, v44
    v_exp_f32 v45, v45
    v_smfmac_f32_32x32x32_bf16 v[92:107], v[128:131], v[68:75], v0
    v_exp_f32 v46, v46
    v_exp_f32 v47, v47
    v_exp_f32 v48, v48
    v_mfma_f32_32x32x16_bf16 v[60:75], v[108:111], v[8:11], v[28:43]
    ds_read_b128 v[108:111], v2 offset:20480
    s_mov_b64 exec, s[72:73]
    ds_read_b128 v[120:123], v3 offset:18432
    ds_read_b128 v[128:131], v3 offset:18944
    s_mov_b64 exec, -1
    v_exp_f32 v49, v49
    v_exp_f32 v50, v50
    v_exp_f32 v51, v51
    v_exp_f32 v52, v52
    v_exp_f32 v53, v53
    s_waitcnt lgkmcnt(3)
    v_smfmac_f32_32x32x32_bf16 v[76:91], v[116:119], v[44:51], v0
    v_exp_f32 v54, v54
    v_exp_f32 v55, v55
    v_exp_f32 v56, v56
    s_cmp_eq_u32 s96, 1
    s_cbranch_scc0 L_nokv8
    s_mov_b32 m0, s84
    s_add_u32 s78, s85, 1024
    buffer_load_dwordx4 v253, s[44:47], s85 offen sc1 lds
    s_add_u32 m0, s84, 1024
    s_add_u32 s84, s84, 8192
    buffer_load_dwordx4 v253, s[44:47], s78 offen sc1 lds
    s_add_u32 s85, s85, 8192
L_nokv8:
    v_exp_f32 v57, v57
    v_exp_f32 v58, v58
    v_exp_f32 v59, v59
    v_exp_f32 v60, v60
    v_exp_f32 v61, v61
    v_smfmac_f32_32x32x32_bf16 v[76:91], v[124:127], v[52:59], v0
    v_exp_f32 v62, v62
    v_exp_f32 v63, v63
    v_exp_f32 v64, v64
    v_mfma_f32_32x32x16_bf16 v[44:59], v[112:115], v[4:7], v[12:27]
    v_exp_f32 v65, v65
    v_exp_f32 v66, v66
    v_exp_f32 v67, v67
    v_exp_f32 v68, v68
    v_exp_f32 v69, v69
    v_smfmac_f32_32x32x32_bf16 v[92:107], v[116:119], v[60:67], v0
    v_exp_f32 v70, v70
    v_exp_f32 v71, v71
    v_exp_f32 v72, v72
    v_exp_f32 v73, v73
    v_exp_f32 v74, v74
    v_exp_f32 v75, v75
    v_exp_f32 v44, v44
    v_exp_f32 v45, v45
    v_smfmac_f32_32x32x32_bf16 v[92:107], v[124:127], v[68:75], v0
    v_exp_f32 v46, v46
    v_exp_f32 v47, v47
    v_exp_f32 v48, v48
    v_mfma_f32_32x32x16_bf16 v[60:75], v[112:115], v[8:11], v[28:43]
    ds_read_b128 v[112:115], v2 offset:22528
    s_mov_b64 exec, s[72:73]
    ds_read_b128 v[116:119], v3 offset:20480
    ds_read_b128 v[124:127], v3 offset:20992
    s_mov_b64 exec, -1
    v_exp_f32 v49, v49
    v_exp_f32 v50, v50
    v_exp_f32 v51, v51
    v_exp_f32 v52, v52
    v_exp_f32 v53, v53
    s_waitcnt lgkmcnt(3)
    v_smfmac_f32_32x32x32_bf16 v[76:91], v[120:123], v[44:51], v0
    v_exp_f32 v54, v54
    v_exp_f32 v55, v55
    v_exp_f32 v56, v56
    s_cmp_eq_u32 s96, 1
    s_cbranch_scc0 L_nokv9
    s_mov_b32 m0, s84
    s_add_u32 s78, s85, 1024
    buffer_load_dwordx4 v253, s[44:47], s85 offen sc1 lds
    s_add_u32 m0, s84, 1024
    s_add_u32 s84, s84, 8192
    buffer_load_dwordx4 v253, s[44:47], s78 offen sc1 lds
    s_add_u32 s85, s85, 8192
L_nokv9:
    v_exp_f32 v57, v57
    v_exp_f32 v58, v58
    v_exp_f32 v59, v59
    v_exp_f32 v60, v60
    v_exp_f32 v61, v61
    v_smfmac_f32_32x32x32_bf16 v[76:91], v[128:131], v[52:59], v0
    v_exp_f32 v62, v62
    v_exp_f32 v63, v63
    v_exp_f32 v64, v64
    v_mfma_f32_32x32x16_bf16 v[44:59], v[108:111], v[4:7], v[12:27]
    v_exp_f32 v65, v65
    v_exp_f32 v66, v66
    v_exp_f32 v67, v67
    v_exp_f32 v68, v68
    v_exp_f32 v69, v69
    v_smfmac_f32_32x32x32_bf16 v[92:107], v[120:123], v[60:67], v0
    v_exp_f32 v70, v70
    v_exp_f32 v71, v71
    v_exp_f32 v72, v72
    v_exp_f32 v73, v73
    v_exp_f32 v74, v74
    v_exp_f32 v75, v75
    v_exp_f32 v44, v44
    v_exp_f32 v45, v45
    v_smfmac_f32_32x32x32_bf16 v[92:107], v[128:131], v[68:75], v0
    v_exp_f32 v46, v46
    v_exp_f32 v47, v47
    v_exp_f32 v48, v48
    v_mfma_f32_32x32x16_bf16 v[60:75], v[108:111], v[8:11], v[28:43]
    ds_read_b128 v[108:111], v2 offset:24576
    s_mov_b64 exec, s[72:73]
    ds_read_b128 v[120:123], v3 offset:22528
    ds_read_b128 v[128:131], v3 offset:23040
    s_mov_b64 exec, -1
    v_exp_f32 v49, v49
    v_exp_f32 v50, v50
    v_exp_f32 v51, v51
    v_exp_f32 v52, v52
    v_exp_f32 v53, v53
    s_waitcnt lgkmcnt(3)
    v_smfmac_f32_32x32x32_bf16 v[76:91], v[116:119], v[44:51], v0
    v_exp_f32 v54, v54
    v_exp_f32 v55, v55
    v_exp_f32 v56, v56
    s_cmp_eq_u32 s96, 1
    s_cbranch_scc0 L_nokv10
    s_mov_b32 m0, s84
    s_add_u32 s78, s85, 1024
    buffer_load_dwordx4 v253, s[44:47], s85 offen sc1 lds
    s_add_u32 m0, s84, 1024
    s_add_u32 s84, s84, 8192
    buffer_load_dwordx4 v253, s[44:47], s78 offen sc1 lds
    s_add_u32 s85, s85, 8192
L_nokv10:
    v_exp_f32 v57, v57
    v_exp_f32 v58, v58
    v_exp_f32 v59, v59
    v_exp_f32 v60, v60
    v_exp_f32 v61, v61
    v_smfmac_f32_32x32x32_bf16 v[76:91], v[124:127], v[52:59], v0
    v_exp_f32 v62, v62
    v_exp_f32 v63, v63
    v_exp_f32 v64, v64
    v_mfma_f32_32x32x16_bf16 v[44:59], v[112:115], v[4:7], v[12:27]
    v_exp_f32 v65, v65
    v_exp_f32 v66, v66
    v_exp_f32 v67, v67
    v_exp_f32 v68, v68
    v_exp_f32 v69, v69
    v_smfmac_f32_32x32x32_bf16 v[92:107], v[116:119], v[60:67], v0
    v_exp_f32 v70, v70
    v_exp_f32 v71, v71
    v_exp_f32 v72, v72
    v_exp_f32 v73, v73
    v_exp_f32 v74, v74
    v_exp_f32 v75, v75
    v_exp_f32 v44, v44
    v_exp_f32 v45, v45
    v_smfmac_f32_32x32x32_bf16 v[92:107], v[124:127], v[68:75], v0
    v_exp_f32 v46, v46
    v_exp_f32 v47, v47
    v_exp_f32 v48, v48
    v_mfma_f32_32x32x16_bf16 v[60:75], v[112:115], v[8:11], v[28:43]
    ds_read_b128 v[112:115], v2 offset:26624
    s_mov_b64 exec, s[72:73]
    ds_read_b128 v[116:119], v3 offset:24576
    ds_read_b128 v[124:127], v3 offset:25088
    s_mov_b64 exec, -1
    v_exp_f32 v49, v49
    v_exp_f32 v50, v50
    v_exp_f32 v51, v51
    v_exp_f32 v52, v52
    v_exp_f32 v53, v53
    s_waitcnt lgkmcnt(3)
    v_smfmac_f32_32x32x32_bf16 v[76:91], v[120:123], v[44:51], v0
    v_exp_f32 v54, v54
    v_exp_f32 v55, v55
    v_exp_f32 v56, v56
    s_cmp_eq_u32 s96, 1
    s_cbranch_scc0 L_nokv11
    s_mov_b32 m0, s84
    s_add_u32 s78, s85, 1024
    buffer_load_dwordx4 v253, s[44:47], s85 offen sc1 lds
    s_add_u32 m0, s84, 1024
    s_add_u32 s84, s84, 8192
    buffer_load_dwordx4 v253, s[44:47], s78 offen sc1 lds
    s_add_u32 s85, s85, 8192
L_nokv11:
    v_exp_f32 v57, v57
    v_exp_f32 v58, v58
    v_exp_f32 v59, v59
    v_exp_f32 v60, v60
    v_exp_f32 v61, v61
    v_smfmac_f32_32x32x32_bf16 v[76:91], v[128:131], v[52:59], v0
    v_exp_f32 v62, v62
    v_exp_f32 v63, v63
    v_exp_f32 v64, v64
    v_mfma_f32_32x32x16_bf16 v[44:59], v[108:111], v[4:7], v[12:27]
    v_exp_f32 v65, v65
    v_exp_f32 v66, v66
    v_exp_f32 v67, v67
    v_exp_f32 v68, v68
    v_exp_f32 v69, v69
    v_smfmac_f32_32x32x32_bf16 v[92:107], v[120:123], v[60:67], v0
    v_exp_f32 v70, v70
    v_exp_f32 v71, v71
    v_exp_f32 v72, v72
    v_exp_f32 v73, v73
    v_exp_f32 v74, v74
    v_exp_f32 v75, v75
    v_exp_f32 v44, v44
    v_exp_f32 v45, v45
    v_smfmac_f32_32x32x32_bf16 v[92:107], v[128:131], v[68:75], v0
    v_exp_f32 v46, v46
    v_exp_f32 v47, v47
    v_exp_f32 v48, v48
    v_mfma_f32_32x32x16_bf16 v[60:75], v[108:111], v[8:11], v[28:43]
    ds_read_b128 v[108:111], v2 offset:28672
    s_mov_b64 exec, s[72:73]
    ds_read_b128 v[120:123], v3 offset:26624
    ds_read_b128 v[128:131], v3 offset:27136
    s_mov_b64 exec, -1
    v_exp_f32 v49, v49
    v_exp_f32 v50, v50
    v_exp_f32 v51, v51
    v_exp_f32 v52, v52
    v_exp_f32 v53, v53
    s_waitcnt lgkmcnt(3)
    v_smfmac_f32_32x32x32_bf16 v[76:91], v[116:119], v[44:51], v0
    v_exp_f32 v54, v54
    v_exp_f32 v55, v55
    v_exp_f32 v56, v56
    s_cmp_eq_u32 s96, 1
    s_cbranch_scc0 L_nokv12
    s_mov_b32 m0, s84
    s_add_u32 s78, s85, 1024
    buffer_load_dwordx4 v253, s[44:47], s85 offen sc1 lds
    s_add_u32 m0, s84, 1024
    s_add_u32 s84, s84, 8192
    buffer_load_dwordx4 v253, s[44:47], s78 offen sc1 lds
    s_add_u32 s85, s85, 8192
L_nokv12:
    v_exp_f32 v57, v57
    v_exp_f32 v58, v58
    v_exp_f32 v59, v59
    v_exp_f32 v60, v60
    v_exp_f32 v61, v61
    v_smfmac_f32_32x32x32_bf16 v[76:91], v[124:127], v[52:59], v0
    v_exp_f32 v62, v62
    v_exp_f32 v63, v63
    v_exp_f32 v64, v64
    v_mfma_f32_32x32x16_bf16 v[44:59], v[112:115], v[4:7], v[12:27]
    v_exp_f32 v65, v65
    v_exp_f32 v66, v66
    v_exp_f32 v67, v67
    v_exp_f32 v68, v68
    v_exp_f32 v69, v69
    v_smfmac_f32_32x32x32_bf16 v[92:107], v[116:119], v[60:67], v0
    v_exp_f32 v70, v70
    v_exp_f32 v71, v71
    v_exp_f32 v72, v72
    v_exp_f32 v73, v73
    v_exp_f32 v74, v74
    v_exp_f32 v75, v75
    v_exp_f32 v44, v44
    v_exp_f32 v45, v45
    v_smfmac_f32_32x32x32_bf16 v[92:107], v[124:127], v[68:75], v0
    v_exp_f32 v46, v46
    v_exp_f32 v47, v47
    v_exp_f32 v48, v48
    v_mfma_f32_32x32x16_bf16 v[60:75], v[112:115], v[8:11], v[28:43]
    ds_read_b128 v[112:115], v2 offset:30720
    s_mov_b64 exec, s[72:73]
    ds_read_b128 v[116:119], v3 offset:28672
    ds_read_b128 v[124:127], v3 offset:29184
    s_mov_b64 exec, -1
    v_exp_f32 v49, v49
    v_exp_f32 v50, v50
    v_exp_f32 v51, v51
    v_exp_f32 v52, v52
    v_exp_f32 v53, v53
    s_waitcnt lgkmcnt(3)
    v_smfmac_f32_32x32x32_bf16 v[76:91], v[120:123], v[44:51], v0
    v_exp_f32 v54, v54
    v_exp_f32 v55, v55
    v_exp_f32 v56, v56
    s_cmp_eq_u32 s96, 1
    s_cbranch_scc0 L_nokv13
    s_mov_b32 m0, s84
    s_add_u32 s78, s85, 1024
    buffer_load_dwordx4 v253, s[44:47], s85 offen sc1 lds
    s_add_u32 m0, s84, 1024
    s_add_u32 s84, s84, 8192
    buffer_load_dwordx4 v253, s[44:47], s78 offen sc1 lds
    s_add_u32 s85, s85, 8192
L_nokv13:
    v_exp_f32 v57, v57
    v_exp_f32 v58, v58
    v_exp_f32 v59, v59
    v_exp_f32 v60, v60
    v_exp_f32 v61, v61
    v_smfmac_f32_32x32x32_bf16 v[76:91], v[128:131], v[52:59], v0
    v_exp_f32 v62, v62
    v_exp_f32 v63, v63
    v_exp_f32 v64, v64
    v_mfma_f32_32x32x16_bf16 v[44:59], v[108:111], v[4:7], v[12:27]
    v_exp_f32 v65, v65
    v_exp_f32 v66, v66
    v_exp_f32 v67, v67
    v_exp_f32 v68, v68
    v_exp_f32 v69, v69
    v_smfmac_f32_32x32x32_bf16 v[92:107], v[120:123], v[60:67], v0
    v_exp_f32 v70, v70
    v_exp_f32 v71, v71
    v_exp_f32 v72, v72
    v_exp_f32 v73, v73
    v_exp_f32 v74, v74
    v_exp_f32 v75, v75
    s_cmp_eq_u32 s74, 1
    s_cbranch_scc0 L_sy3_done
    s_cmp_ge_u32 s64, 4
    s_cbranch_scc0 L_sy3_spin
    s_waitcnt vmcnt(14)
    v_mov_b32 v254, 1
    s_mov_b64 exec, 1
    ds_add_u32 v253, v254 offset:31744
    s_mov_b64 exec, -1
L_sy3_spin:
    ds_read_b32 v254, v253 offset:31744
    s_waitcnt lgkmcnt(0)
    v_readfirstlane_b32 s78, v254
    s_cmp_ge_u32 s78, 12
    s_cbranch_scc0 L_sy3_spin
L_sy3_done:
    v_exp_f32 v44, v44
    v_exp_f32 v45, v45
    v_smfmac_f32_32x32x32_bf16 v[92:107], v[128:131], v[68:75], v0
    v_exp_f32 v46, v46
    v_exp_f32 v47, v47
    v_exp_f32 v48, v48
    v_mfma_f32_32x32x16_bf16 v[60:75], v[108:111], v[8:11], v[28:43]
    ds_read_b128 v[108:111], v2 offset:32768
    s_mov_b64 exec, s[72:73]
    ds_read_b128 v[120:123], v3 offset:30720
    ds_read_b128 v[128:131], v3 offset:31232
    s_mov_b64 exec, -1
    v_exp_f32 v49, v49
    v_exp_f32 v50, v50
    v_exp_f32 v51, v51
    v_exp_f32 v52, v52
    v_exp_f32 v53, v53
    s_waitcnt lgkmcnt(3)
    v_smfmac_f32_32x32x32_bf16 v[76:91], v[116:119], v[44:51], v0
    v_exp_f32 v54, v54
    v_exp_f32 v55, v55
    v_exp_f32 v56, v56
    s_cmp_eq_u32 s96, 1
    s_cbranch_scc0 L_nokv14
    s_mov_b32 m0, s84
    s_add_u32 s78, s85, 1024
    buffer_load_dwordx4 v253, s[44:47], s85 offen sc1 lds
    s_add_u32 m0, s84, 1024
    s_add_u32 s84, s84, 8192
    buffer_load_dwordx4 v253, s[44:47], s78 offen sc1 lds
    s_add_u32 s85, s85, 8192
L_nokv14:
    v_exp_f32 v57, v57
    v_exp_f32 v58, v58
    v_exp_f32 v59, v59
    v_exp_f32 v60, v60
    v_exp_f32 v61, v61
    v_smfmac_f32_32x32x32_bf16 v[76:91], v[124:127], v[52:59], v0
    v_exp_f32 v62, v62
    v_exp_f32 v63, v63
    v_exp_f32 v64, v64
    v_mfma_f32_32x32x16_bf16 v[44:59], v[112:115], v[4:7], v[12:27]
    v_exp_f32 v65, v65
    v_exp_f32 v66, v66
    v_exp_f32 v67, v67
    v_exp_f32 v68, v68
    v_exp_f32 v69, v69
    v_smfmac_f32_32x32x32_bf16 v[92:107], v[116:119], v[60:67], v0
    v_exp_f32 v70, v70
    v_exp_f32 v71, v71
    v_exp_f32 v72, v72
    v_exp_f32 v73, v73
    v_exp_f32 v74, v74
    v_exp_f32 v75, v75
    v_exp_f32 v44, v44
    v_exp_f32 v45, v45
    v_smfmac_f32_32x32x32_bf16 v[92:107], v[124:127], v[68:75], v0
    v_exp_f32 v46, v46
    v_exp_f32 v47, v47
    v_exp_f32 v48, v48
    v_mfma_f32_32x32x16_bf16 v[60:75], v[112:115], v[8:11], v[28:43]
    ds_read_b128 v[112:115], v2 offset:34816
    s_mov_b64 exec, s[72:73]
    ds_read_b128 v[116:119], v3 offset:32768
    ds_read_b128 v[124:127], v3 offset:33280
    s_mov_b64 exec, -1
    v_exp_f32 v49, v49
    v_exp_f32 v50, v50
    v_exp_f32 v51, v51
    v_exp_f32 v52, v52
    v_exp_f32 v53, v53
    s_waitcnt lgkmcnt(3)
    v_smfmac_f32_32x32x32_bf16 v[76:91], v[120:123], v[44:51], v0
    v_exp_f32 v54, v54
    v_exp_f32 v55, v55
    v_exp_f32 v56, v56
    v_exp_f32 v57, v57
    v_exp_f32 v58, v58
    v_exp_f32 v59, v59
    v_exp_f32 v60, v60
    v_exp_f32 v61, v61
    v_smfmac_f32_32x32x32_bf16 v[76:91], v[128:131], v[52:59], v0
    v_exp_f32 v62, v62
    v_exp_f32 v63, v63
    v_exp_f32 v64, v64
    v_mfma_f32_32x32x16_bf16 v[44:59], v[108:111], v[4:7], v[12:27]
    v_exp_f32 v65, v65
    v_exp_f32 v66, v66
    v_exp_f32 v67, v67
    v_exp_f32 v68, v68
    v_exp_f32 v69, v69
    v_smfmac_f32_32x32x32_bf16 v[92:107], v[120:123], v[60:67], v0
    v_exp_f32 v70, v70
    v_exp_f32 v71, v71
    v_exp_f32 v72, v72
    v_exp_f32 v73, v73
    v_exp_f32 v74, v74
    v_exp_f32 v75, v75
    v_exp_f32 v44, v44
    v_exp_f32 v45, v45
    v_smfmac_f32_32x32x32_bf16 v[92:107], v[128:131], v[68:75], v0
    v_exp_f32 v46, v46
    v_exp_f32 v47, v47
    v_exp_f32 v48, v48
    v_mfma_f32_32x32x16_bf16 v[60:75], v[108:111], v[8:11], v[28:43]
    ds_read_b128 v[108:111], v2 offset:36864
    s_mov_b64 exec, s[72:73]
    ds_read_b128 v[120:123], v3 offset:34816
    ds_read_b128 v[128:131], v3 offset:35328
    s_mov_b64 exec, -1
    v_exp_f32 v49, v49
    v_exp_f32 v50, v50
    v_exp_f32 v51, v51
    v_exp_f32 v52, v52
    v_exp_f32 v53, v53
    s_waitcnt lgkmcnt(3)
    v_smfmac_f32_32x32x32_bf16 v[76:91], v[116:119], v[44:51], v0
    v_exp_f32 v54, v54
    v_exp_f32 v55, v55
    v_exp_f32 v56, v56
    s_lshl_b32 s78, s64, 12
    s_add_u32 m0, s78, 0
    s_mov_b32 s79, 0
    buffer_load_dwordx4 v134, s[52:55], s79 offen lds
    v_exp_f32 v57, v57
    v_exp_f32 v58, v58
    v_exp_f32 v59, v59
    v_exp_f32 v60, v60
    v_exp_f32 v61, v61
    v_smfmac_f32_32x32x32_bf16 v[76:91], v[124:127], v[52:59], v0
    v_exp_f32 v62, v62
    v_exp_f32 v63, v63
    v_exp_f32 v64, v64
    v_mfma_f32_32x32x16_bf16 v[44:59], v[112:115], v[4:7], v[12:27]
    v_exp_f32 v65, v65
    v_exp_f32 v66, v66
    v_exp_f32 v67, v67
    v_exp_f32 v68, v68
    v_exp_f32 v69, v69
    v_smfmac_f32_32x32x32_bf16 v[92:107], v[116:119], v[60:67], v0
    v_exp_f32 v70, v70
    v_exp_f32 v71, v71
    v_exp_f32 v72, v72
    v_exp_f32 v73, v73
    v_exp_f32 v74, v74
    v_exp_f32 v75, v75
    v_exp_f32 v44, v44
    v_exp_f32 v45, v45
    v_smfmac_f32_32x32x32_bf16 v[92:107], v[124:127], v[68:75], v0
    v_exp_f32 v46, v46
    v_exp_f32 v47, v47
    v_exp_f32 v48, v48
    v_mfma_f32_32x32x16_bf16 v[60:75], v[112:115], v[8:11], v[28:43]
    ds_read_b128 v[112:115], v2 offset:38912
    s_mov_b64 exec, s[72:73]
    ds_read_b128 v[116:119], v3 offset:36864
    ds_read_b128 v[124:127], v3 offset:37376
    s_mov_b64 exec, -1
    v_exp_f32 v49, v49
    v_exp_f32 v50, v50
    v_exp_f32 v51, v51
    v_exp_f32 v52, v52
    v_exp_f32 v53, v53
    s_waitcnt lgkmcnt(3)
    v_smfmac_f32_32x32x32_bf16 v[76:91], v[120:123], v[44:51], v0
    v_exp_f32 v54, v54
    v_exp_f32 v55, v55
    v_exp_f32 v56, v56
    s_lshl_b32 s78, s64, 12
    s_add_u32 m0, s78, 1024
    s_mov_b32 s79, 16384
    buffer_load_dwordx4 v134, s[52:55], s79 offen lds
    v_exp_f32 v57, v57
    v_exp_f32 v58, v58
    v_exp_f32 v59, v59
    v_exp_f32 v60, v60
    v_exp_f32 v61, v61
    v_smfmac_f32_32x32x32_bf16 v[76:91], v[128:131], v[52:59], v0
    v_exp_f32 v62, v62
    v_exp_f32 v63, v63
    v_exp_f32 v64, v64
    v_mfma_f32_32x32x16_bf16 v[44:59], v[108:111], v[4:7], v[12:27]
    v_exp_f32 v65, v65
    v_exp_f32 v66, v66
    v_exp_f32 v67, v67
    v_exp_f32 v68, v68
    v_exp_f32 v69, v69
    v_smfmac_f32_32x32x32_bf16 v[92:107], v[120:123], v[60:67], v0
    v_exp_f32 v70, v70
    v_exp_f32 v71, v71
    v_exp_f32 v72, v72
    v_exp_f32 v73, v73
    v_exp_f32 v74, v74
    v_exp_f32 v75, v75
    v_exp_f32 v44, v44
    v_exp_f32 v45, v45
    v_smfmac_f32_32x32x32_bf16 v[92:107], v[128:131], v[68:75], v0
    v_exp_f32 v46, v46
    v_exp_f32 v47, v47
    v_exp_f32 v48, v48
    v_mfma_f32_32x32x16_bf16 v[60:75], v[108:111], v[8:11], v[28:43]
    ds_read_b128 v[108:111], v2 offset:40960
    s_mov_b64 exec, s[72:73]
    ds_read_b128 v[120:123], v3 offset:38912
    ds_read_b128 v[128:131], v3 offset:39424
    s_mov_b64 exec, -1
    v_exp_f32 v49, v49
    v_exp_f32 v50, v50
    v_exp_f32 v51, v51
    v_exp_f32 v52, v52
    v_exp_f32 v53, v53
    s_waitcnt lgkmcnt(3)
    v_smfmac_f32_32x32x32_bf16 v[76:91], v[116:119], v[44:51], v0
    v_exp_f32 v54, v54
    v_exp_f32 v55, v55
    v_exp_f32 v56, v56
    s_lshl_b32 s78, s64, 12
    s_add_u32 m0, s78, 2048
    s_mov_b32 s79, 32768
    buffer_load_dwordx4 v134, s[52:55], s79 offen lds
    v_exp_f32 v57, v57
    v_exp_f32 v58, v58
    v_exp_f32 v59, v59
    v_exp_f32 v60, v60
    v_exp_f32 v61, v61
    v_smfmac_f32_32x32x32_bf16 v[76:91], v[124:127], v[52:59], v0
    v_exp_f32 v62, v62
    v_exp_f32 v63, v63
    v_exp_f32 v64, v64
    v_mfma_f32_32x32x16_bf16 v[44:59], v[112:115], v[4:7], v[12:27]
    v_exp_f32 v65, v65
    v_exp_f32 v66, v66
    v_exp_f32 v67, v67
    s_waitcnt vmcnt(2)
    ds_read_b64_tr_b16 v[136:137], v135 offset:0
    ds_read_b64_tr_b16 v[138:139], v135 offset:512
    v_exp_f32 v68, v68
    v_exp_f32 v69, v69
    v_smfmac_f32_32x32x32_bf16 v[92:107], v[116:119], v[60:67], v0
    v_exp_f32 v70, v70
    v_exp_f32 v71, v71
    v_exp_f32 v72, v72
    v_exp_f32 v73, v73
    v_exp_f32 v74, v74
    v_exp_f32 v75, v75
    v_exp_f32 v44, v44
    v_exp_f32 v45, v45
    v_smfmac_f32_32x32x32_bf16 v[92:107], v[124:127], v[68:75], v0
    v_exp_f32 v46, v46
    v_exp_f32 v47, v47
    v_exp_f32 v48, v48
    v_mfma_f32_32x32x16_bf16 v[60:75], v[112:115], v[8:11], v[28:43]
    ds_read_b128 v[112:115], v2 offset:43008
    s_mov_b64 exec, s[72:73]
    ds_read_b128 v[116:119], v3 offset:40960
    ds_read_b128 v[124:127], v3 offset:41472
    s_mov_b64 exec, -1
    v_exp_f32 v49, v49
    v_exp_f32 v50, v50
    v_exp_f32 v51, v51
    v_exp_f32 v52, v52
    v_exp_f32 v53, v53
    s_waitcnt lgkmcnt(3)
    v_smfmac_f32_32x32x32_bf16 v[76:91], v[120:123], v[44:51], v0
    v_exp_f32 v54, v54
    v_exp_f32 v55, v55
    v_exp_f32 v56, v56
    s_lshl_b32 s78, s64, 12
    s_add_u32 m0, s78, 0
    s_mov_b32 s79, 49152
    buffer_load_dwordx4 v134, s[52:55], s79 offen lds
    v_exp_f32 v57, v57
    v_exp_f32 v58, v58
    v_exp_f32 v59, v59
    v_exp_f32 v60, v60
    v_exp_f32 v61, v61
    v_smfmac_f32_32x32x32_bf16 v[76:91], v[128:131], v[52:59], v0
    v_exp_f32 v62, v62
    v_exp_f32 v63, v63
    v_exp_f32 v64, v64
    v_mfma_f32_32x32x16_bf16 v[44:59], v[108:111], v[4:7], v[12:27]
    v_exp_f32 v65, v65
    v_exp_f32 v66, v66
    v_exp_f32 v67, v67
    s_waitcnt vmcnt(2)
    ds_read_b64_tr_b16 v[140:141], v135 offset:1024
    ds_read_b64_tr_b16 v[142:143], v135 offset:1536
    v_exp_f32 v68, v68
    v_exp_f32 v69, v69
    v_smfmac_f32_32x32x32_bf16 v[92:107], v[120:123], v[60:67], v0
    v_exp_f32 v70, v70
    v_exp_f32 v71, v71
    v_exp_f32 v72, v72
    v_exp_f32 v73, v73
    v_exp_f32 v74, v74
    v_exp_f32 v75, v75
    v_exp_f32 v44, v44
    v_exp_f32 v45, v45
    v_smfmac_f32_32x32x32_bf16 v[92:107], v[128:131], v[68:75], v0
    v_exp_f32 v46, v46
    v_exp_f32 v47, v47
    v_exp_f32 v48, v48
    v_mfma_f32_32x32x16_bf16 v[60:75], v[108:111], v[8:11], v[28:43]
    ds_read_b128 v[108:111], v2 offset:45056
    s_mov_b64 exec, s[72:73]
    ds_read_b128 v[120:123], v3 offset:43008
    ds_read_b128 v[128:131], v3 offset:43520
    s_mov_b64 exec, -1
    v_exp_f32 v49, v49
    v_exp_f32 v50, v50
    v_exp_f32 v51, v51
    v_exp_f32 v52, v52
    v_exp_f32 v53, v53
    s_waitcnt lgkmcnt(3)
    v_smfmac_f32_32x32x32_bf16 v[76:91], v[116:119], v[44:51], v0
    v_exp_f32 v54, v54
    v_exp_f32 v55, v55
    v_exp_f32 v56, v56
    s_lshl_b32 s78, s64, 12
    s_add_u32 m0, s78, 1024
    s_mov_b32 s79, 65536
    buffer_load_dwordx4 v134, s[52:55], s79 offen lds
    v_exp_f32 v57, v57
    v_exp_f32 v58, v58
    v_exp_f32 v59, v59
    v_exp_f32 v60, v60
    v_exp_f32 v61, v61
    v_smfmac_f32_32x32x32_bf16 v[76:91], v[124:127], v[52:59], v0
    v_exp_f32 v62, v62
    v_exp_f32 v63, v63
    v_exp_f32 v64, v64
    v_mfma_f32_32x32x16_bf16 v[44:59], v[112:115], v[4:7], v[12:27]
    v_exp_f32 v65, v65
    v_exp_f32 v66, v66
    v_exp_f32 v67, v67
    s_waitcnt vmcnt(2)
    ds_read_b64_tr_b16 v[144:145], v135 offset:2048
    ds_read_b64_tr_b16 v[146:147], v135 offset:2560
    v_exp_f32 v68, v68
    v_exp_f32 v69, v69
    v_smfmac_f32_32x32x32_bf16 v[92:107], v[116:119], v[60:67], v0
    v_exp_f32 v70, v70
    v_exp_f32 v71, v71
    v_exp_f32 v72, v72
    v_exp_f32 v73, v73
    v_exp_f32 v74, v74
    v_exp_f32 v75, v75
    v_exp_f32 v44, v44
    v_exp_f32 v45, v45
    v_smfmac_f32_32x32x32_bf16 v[92:107], v[124:127], v[68:75], v0
    v_exp_f32 v46, v46
    v_exp_f32 v47, v47
    v_exp_f32 v48, v48
    v_mfma_f32_32x32x16_bf16 v[60:75], v[112:115], v[8:11], v[28:43]
    ds_read_b128 v[112:115], v2 offset:47104
    s_mov_b64 exec, s[72:73]
    ds_read_b128 v[116:119], v3 offset:45056
    ds_read_b128 v[124:127], v3 offset:45568
    s_mov_b64 exec, -1
    v_exp_f32 v49, v49
    v_exp_f32 v50, v50
    v_exp_f32 v51, v51
    v_exp_f32 v52, v52
    v_exp_f32 v53, v53
    s_waitcnt lgkmcnt(3)
    v_smfmac_f32_32x32x32_bf16 v[76:91], v[120:123], v[44:51], v0
    v_exp_f32 v54, v54
    v_exp_f32 v55, v55
    v_exp_f32 v56, v56
    s_lshl_b32 s78, s64, 12
    s_add_u32 m0, s78, 2048
    s_mov_b32 s79, 81920
    buffer_load_dwordx4 v134, s[52:55], s79 offen lds
    v_exp_f32 v57, v57
    v_exp_f32 v58, v58
    v_exp_f32 v59, v59
    v_exp_f32 v60, v60
    v_exp_f32 v61, v61
    v_smfmac_f32_32x32x32_bf16 v[76:91], v[128:131], v[52:59], v0
    v_exp_f32 v62, v62
    v_exp_f32 v63, v63
    v_exp_f32 v64, v64
    v_mfma_f32_32x32x16_bf16 v[44:59], v[108:111], v[4:7], v[12:27]
    v_exp_f32 v65, v65
    v_exp_f32 v66, v66
    v_exp_f32 v67, v67
    s_waitcnt vmcnt(2)
    ds_read_b64_tr_b16 v[148:149], v135 offset:0
    ds_read_b64_tr_b16 v[150:151], v135 offset:512
    v_exp_f32 v68, v68
    v_exp_f32 v69, v69
    v_smfmac_f32_32x32x32_bf16 v[92:107], v[120:123], v[60:67], v0
    v_exp_f32 v70, v70
    v_exp_f32 v71, v71
    v_exp_f32 v72, v72
    v_exp_f32 v73, v73
    v_exp_f32 v74, v74
    v_exp_f32 v75, v75
    v_exp_f32 v44, v44
    v_exp_f32 v45, v45
    v_smfmac_f32_32x32x32_bf16 v[92:107], v[128:131], v[68:75], v0
    v_exp_f32 v46, v46
    v_exp_f32 v47, v47
    v_exp_f32 v48, v48
    v_mfma_f32_32x32x16_bf16 v[60:75], v[108:111], v[8:11], v[28:43]
    ds_read_b128 v[108:111], v2 offset:49152
    s_mov_b64 exec, s[72:73]
    ds_read_b128 v[120:123], v3 offset:47104
    ds_read_b128 v[128:131], v3 offset:47616
    s_mov_b64 exec, -1
    v_exp_f32 v49, v49
    v_exp_f32 v50, v50
    v_exp_f32 v51, v51
    v_exp_f32 v52, v52
    v_exp_f32 v53, v53
    s_waitcnt lgkmcnt(3)
    v_smfmac_f32_32x32x32_bf16 v[76:91], v[116:119], v[44:51], v0
    v_exp_f32 v54, v54
    v_exp_f32 v55, v55
    v_exp_f32 v56, v56
    s_lshl_b32 s78, s64, 12
    s_add_u32 m0, s78, 0
    s_mov_b32 s79, 98304
    buffer_load_dwordx4 v134, s[52:55], s79 offen lds
    v_exp_f32 v57, v57
    v_exp_f32 v58, v58
    v_exp_f32 v59, v59
    v_exp_f32 v60, v60
    v_exp_f32 v61, v61
    v_smfmac_f32_32x32x32_bf16 v[76:91], v[124:127], v[52:59], v0
    v_exp_f32 v62, v62
    v_exp_f32 v63, v63
    v_exp_f32 v64, v64
    v_mfma_f32_32x32x16_bf16 v[44:59], v[112:115], v[4:7], v[12:27]
    v_exp_f32 v65, v65
    v_exp_f32 v66, v66
    v_exp_f32 v67, v67
    s_waitcnt vmcnt(2)
    ds_read_b64_tr_b16 v[152:153], v135 offset:1024
    ds_read_b64_tr_b16 v[154:155], v135 offset:1536
    v_exp_f32 v68, v68
    v_exp_f32 v69, v69
    v_smfmac_f32_32x32x32_bf16 v[92:107], v[116:119], v[60:67], v0
    v_exp_f32 v70, v70
    v_exp_f32 v71, v71
    v_exp_f32 v72, v72
    v_exp_f32 v73, v73
    v_exp_f32 v74, v74
    v_exp_f32 v75, v75
    v_exp_f32 v44, v44
    v_exp_f32 v45, v45
    v_smfmac_f32_32x32x32_bf16 v[92:107], v[124:127], v[68:75], v0
    v_exp_f32 v46, v46
    v_exp_f32 v47, v47
    v_exp_f32 v48, v48
    v_mfma_f32_32x32x16_bf16 v[60:75], v[112:115], v[8:11], v[28:43]
    ds_read_b128 v[112:115], v2 offset:51200
    s_mov_b64 exec, s[72:73]
    ds_read_b128 v[116:119], v3 offset:49152
    ds_read_b128 v[124:127], v3 offset:49664
    s_mov_b64 exec, -1
    v_exp_f32 v49, v49
    v_exp_f32 v50, v50
    v_exp_f32 v51, v51
    v_exp_f32 v52, v52
    v_exp_f32 v53, v53
    s_waitcnt lgkmcnt(3)
    v_smfmac_f32_32x32x32_bf16 v[76:91], v[120:123], v[44:51], v0
    v_exp_f32 v54, v54
    v_exp_f32 v55, v55
    v_exp_f32 v56, v56
    s_lshl_b32 s78, s64, 12
    s_add_u32 m0, s78, 1024
    s_mov_b32 s79, 114688
    buffer_load_dwordx4 v134, s[52:55], s79 offen lds
    v_exp_f32 v57, v57
    v_exp_f32 v58, v58
    v_exp_f32 v59, v59
    v_exp_f32 v60, v60
    v_exp_f32 v61, v61
    v_smfmac_f32_32x32x32_bf16 v[76:91], v[128:131], v[52:59], v0
    v_exp_f32 v62, v62
    v_exp_f32 v63, v63
    v_exp_f32 v64, v64
    v_mfma_f32_32x32x16_bf16 v[44:59], v[108:111], v[4:7], v[12:27]
    v_exp_f32 v65, v65
    v_exp_f32 v66, v66
    v_exp_f32 v67, v67
    s_waitcnt vmcnt(2)
    ds_read_b64_tr_b16 v[156:157], v135 offset:2048
    ds_read_b64_tr_b16 v[158:159], v135 offset:2560
    v_exp_f32 v68, v68
    v_exp_f32 v69, v69
    v_smfmac_f32_32x32x32_bf16 v[92:107], v[120:123], v[60:67], v0
    v_exp_f32 v70, v70
    v_exp_f32 v71, v71
    v_exp_f32 v72, v72
    v_exp_f32 v73, v73
    v_exp_f32 v74, v74
    v_exp_f32 v75, v75
    v_exp_f32 v44, v44
    v_exp_f32 v45, v45
    v_smfmac_f32_32x32x32_bf16 v[92:107], v[128:131], v[68:75], v0
    v_exp_f32 v46, v46
    v_exp_f32 v47, v47
    v_exp_f32 v48, v48
    v_mfma_f32_32x32x16_bf16 v[60:75], v[108:111], v[8:11], v[28:43]
    ds_read_b128 v[108:111], v2 offset:53248
    s_mov_b64 exec, s[72:73]
    ds_read_b128 v[120:123], v3 offset:51200
    ds_read_b128 v[128:131], v3 offset:51712
    s_mov_b64 exec, -1
    v_exp_f32 v49, v49
    v_exp_f32 v50, v50
    v_exp_f32 v51, v51
    v_exp_f32 v52, v52
    v_exp_f32 v53, v53
    s_waitcnt lgkmcnt(3)
    v_smfmac_f32_32x32x32_bf16 v[76:91], v[116:119], v[44:51], v0
    v_exp_f32 v54, v54
    v_exp_f32 v55, v55
    v_exp_f32 v56, v56
    s_lshl_b32 s78, s64, 12
    s_add_u32 m0, s78, 2048
    s_mov_b32 s79, 131072
    buffer_load_dwordx4 v134, s[52:55], s79 offen lds
    v_exp_f32 v57, v57
    v_exp_f32 v58, v58
    v_exp_f32 v59, v59
    v_exp_f32 v60, v60
    v_exp_f32 v61, v61
    v_smfmac_f32_32x32x32_bf16 v[76:91], v[124:127], v[52:59], v0
    v_exp_f32 v62, v62
    v_exp_f32 v63, v63
    v_exp_f32 v64, v64
    v_mfma_f32_32x32x16_bf16 v[44:59], v[112:115], v[4:7], v[12:27]
    v_exp_f32 v65, v65
    v_exp_f32 v66, v66
    v_exp_f32 v67, v67
    s_waitcnt vmcnt(2)
    ds_read_b64_tr_b16 v[160:161], v135 offset:0
    ds_read_b64_tr_b16 v[162:163], v135 offset:512
    v_exp_f32 v68, v68
    v_exp_f32 v69, v69
    v_smfmac_f32_32x32x32_bf16 v[92:107], v[116:119], v[60:67], v0
    v_exp_f32 v70, v70
    v_exp_f32 v71, v71
    v_exp_f32 v72, v72
    v_exp_f32 v73, v73
    v_exp_f32 v74, v74
    v_exp_f32 v75, v75
    v_exp_f32 v44, v44
    v_exp_f32 v45, v45
    v_smfmac_f32_32x32x32_bf16 v[92:107], v[124:127], v[68:75], v0
    v_exp_f32 v46, v46
    v_exp_f32 v47, v47
    v_exp_f32 v48, v48
    v_mfma_f32_32x32x16_bf16 v[60:75], v[112:115], v[8:11], v[28:43]
    ds_read_b128 v[112:115], v2 offset:55296
    s_mov_b64 exec, s[72:73]
    ds_read_b128 v[116:119], v3 offset:53248
    ds_read_b128 v[124:127], v3 offset:53760
    s_mov_b64 exec, -1
    v_exp_f32 v49, v49
    v_exp_f32 v50, v50
    v_exp_f32 v51, v51
    v_exp_f32 v52, v52
    v_exp_f32 v53, v53
    s_waitcnt lgkmcnt(3)
    v_smfmac_f32_32x32x32_bf16 v[76:91], v[120:123], v[44:51], v0
    v_exp_f32 v54, v54
    v_exp_f32 v55, v55
    v_exp_f32 v56, v56
    s_lshl_b32 s78, s64, 12
    s_add_u32 m0, s78, 0
    s_mov_b32 s79, 147456
    buffer_load_dwordx4 v134, s[52:55], s79 offen lds
    v_exp_f32 v57, v57
    v_exp_f32 v58, v58
    v_exp_f32 v59, v59
    v_exp_f32 v60, v60
    v_exp_f32 v61, v61
    v_smfmac_f32_32x32x32_bf16 v[76:91], v[128:131], v[52:59], v0
    v_exp_f32 v62, v62
    v_exp_f32 v63, v63
    v_exp_f32 v64, v64
    v_mfma_f32_32x32x16_bf16 v[44:59], v[108:111], v[4:7], v[12:27]
    v_exp_f32 v65, v65
    v_exp_f32 v66, v66
    v_exp_f32 v67, v67
    s_waitcnt vmcnt(2)
    ds_read_b64_tr_b16 v[164:165], v135 offset:1024
    ds_read_b64_tr_b16 v[166:167], v135 offset:1536
    v_exp_f32 v68, v68
    v_exp_f32 v69, v69
    v_smfmac_f32_32x32x32_bf16 v[92:107], v[120:123], v[60:67], v0
    v_exp_f32 v70, v70
    v_exp_f32 v71, v71
    v_exp_f32 v72, v72
    v_exp_f32 v73, v73
    v_exp_f32 v74, v74
    v_exp_f32 v75, v75
    v_exp_f32 v44, v44
    v_exp_f32 v45, v45
    v_smfmac_f32_32x32x32_bf16 v[92:107], v[128:131], v[68:75], v0
    v_exp_f32 v46, v46
    v_exp_f32 v47, v47
    v_exp_f32 v48, v48
    v_mfma_f32_32x32x16_bf16 v[60:75], v[108:111], v[8:11], v[28:43]
    ds_read_b128 v[108:111], v2 offset:57344
    s_mov_b64 exec, s[72:73]
    ds_read_b128 v[120:123], v3 offset:55296
    ds_read_b128 v[128:131], v3 offset:55808
    s_mov_b64 exec, -1
    v_exp_f32 v49, v49
    v_exp_f32 v50, v50
    v_exp_f32 v51, v51
    v_exp_f32 v52, v52
    v_exp_f32 v53, v53
    s_waitcnt lgkmcnt(3)
    v_smfmac_f32_32x32x32_bf16 v[76:91], v[116:119], v[44:51], v0
    v_exp_f32 v54, v54
    v_exp_f32 v55, v55
    v_exp_f32 v56, v56
    s_lshl_b32 s78, s64, 12
    s_add_u32 m0, s78, 1024
    s_mov_b32 s79, 163840
    buffer_load_dwordx4 v134, s[52:55], s79 offen lds
    v_exp_f32 v57, v57
    v_exp_f32 v58, v58
    v_exp_f32 v59, v59
    v_exp_f32 v60, v60
    v_exp_f32 v61, v61
    v_smfmac_f32_32x32x32_bf16 v[76:91], v[124:127], v[52:59], v0
    v_exp_f32 v62, v62
    v_exp_f32 v63, v63
    v_exp_f32 v64, v64
    v_mfma_f32_32x32x16_bf16 v[44:59], v[112:115], v[4:7], v[12:27]
    v_exp_f32 v65, v65
    v_exp_f32 v66, v66
    v_exp_f32 v67, v67
    s_waitcnt vmcnt(2)
    ds_read_b64_tr_b16 v[168:169], v135 offset:2048
    ds_read_b64_tr_b16 v[170:171], v135 offset:2560
    v_exp_f32 v68, v68
    v_exp_f32 v69, v69
    v_smfmac_f32_32x32x32_bf16 v[92:107], v[116:119], v[60:67], v0
    v_exp_f32 v70, v70
    v_exp_f32 v71, v71
    v_exp_f32 v72, v72
    v_exp_f32 v73, v73
    v_exp_f32 v74, v74
    v_exp_f32 v75, v75
    v_exp_f32 v44, v44
    v_exp_f32 v45, v45
    v_smfmac_f32_32x32x32_bf16 v[92:107], v[124:127], v[68:75], v0
    v_exp_f32 v46, v46
    v_exp_f32 v47, v47
    v_exp_f32 v48, v48
    v_mfma_f32_32x32x16_bf16 v[60:75], v[112:115], v[8:11], v[28:43]
    ds_read_b128 v[112:115], v2 offset:59392
    s_mov_b64 exec, s[72:73]
    ds_read_b128 v[116:119], v3 offset:57344
    ds_read_b128 v[124:127], v3 offset:57856
    s_mov_b64 exec, -1
    v_exp_f32 v49, v49
    v_exp_f32 v50, v50
    v_exp_f32 v51, v51
    v_exp_f32 v52, v52
    v_exp_f32 v53, v53
    s_waitcnt lgkmcnt(3)
    v_smfmac_f32_32x32x32_bf16 v[76:91], v[120:123], v[44:51], v0
    v_exp_f32 v54, v54
    v_exp_f32 v55, v55
    v_exp_f32 v56, v56
    s_lshl_b32 s78, s64, 12
    s_add_u32 m0, s78, 2048
    s_mov_b32 s79, 180224
    buffer_load_dwordx4 v134, s[52:55], s79 offen lds
    v_exp_f32 v57, v57
    v_exp_f32 v58, v58
    v_exp_f32 v59, v59
    v_exp_f32 v60, v60
    v_exp_f32 v61, v61
    v_smfmac_f32_32x32x32_bf16 v[76:91], v[128:131], v[52:59], v0
    v_exp_f32 v62, v62
    v_exp_f32 v63, v63
    v_exp_f32 v64, v64
    v_mfma_f32_32x32x16_bf16 v[44:59], v[108:111], v[4:7], v[12:27]
    v_exp_f32 v65, v65
    v_exp_f32 v66, v66
    v_exp_f32 v67, v67
    s_waitcnt vmcnt(2)
    ds_read_b64_tr_b16 v[172:173], v135 offset:0
    ds_read_b64_tr_b16 v[174:175], v135 offset:512
    v_exp_f32 v68, v68
    v_exp_f32 v69, v69
    v_smfmac_f32_32x32x32_bf16 v[92:107], v[120:123], v[60:67], v0
    v_exp_f32 v70, v70
    v_exp_f32 v71, v71
    v_exp_f32 v72, v72
    v_exp_f32 v73, v73
    v_exp_f32 v74, v74
    v_exp_f32 v75, v75
    v_exp_f32 v44, v44
    v_exp_f32 v45, v45
    v_smfmac_f32_32x32x32_bf16 v[92:107], v[128:131], v[68:75], v0
    v_exp_f32 v46, v46
    v_exp_f32 v47, v47
    v_exp_f32 v48, v48
    v_mfma_f32_32x32x16_bf16 v[60:75], v[108:111], v[8:11], v[28:43]
    ds_read_b128 v[108:111], v2 offset:61440
    s_mov_b64 exec, s[72:73]
    ds_read_b128 v[120:123], v3 offset:59392
    ds_read_b128 v[128:131], v3 offset:59904
    s_mov_b64 exec, -1
    v_exp_f32 v49, v49
    v_exp_f32 v50, v50
    v_exp_f32 v51, v51
    v_exp_f32 v52, v52
    v_exp_f32 v53, v53
    s_waitcnt lgkmcnt(3)
    v_smfmac_f32_32x32x32_bf16 v[76:91], v[116:119], v[44:51], v0
    v_exp_f32 v54, v54
    v_exp_f32 v55, v55
    v_exp_f32 v56, v56
    s_lshl_b32 s78, s64, 12
    s_add_u32 m0, s78, 0
    s_mov_b32 s79, 196608
    buffer_load_dwordx4 v134, s[52:55], s79 offen lds
    v_exp_f32 v57, v57
    v_exp_f32 v58, v58
    v_exp_f32 v59, v59
    v_exp_f32 v60, v60
    v_exp_f32 v61, v61
    v_smfmac_f32_32x32x32_bf16 v[76:91], v[124:127], v[52:59], v0
    v_exp_f32 v62, v62
    v_exp_f32 v63, v63
    v_exp_f32 v64, v64
    v_mfma_f32_32x32x16_bf16 v[44:59], v[112:115], v[4:7], v[12:27]
    v_exp_f32 v65, v65
    v_exp_f32 v66, v66
    v_exp_f32 v67, v67
    s_waitcnt vmcnt(2)
    ds_read_b64_tr_b16 v[176:177], v135 offset:1024
    ds_read_b64_tr_b16 v[178:179], v135 offset:1536
    v_exp_f32 v68, v68
    v_exp_f32 v69, v69
    v_smfmac_f32_32x32x32_bf16 v[92:107], v[116:119], v[60:67], v0
    v_exp_f32 v70, v70
    v_exp_f32 v71, v71
    v_exp_f32 v72, v72
    v_exp_f32 v73, v73
    v_exp_f32 v74, v74
    v_exp_f32 v75, v75
    v_exp_f32 v44, v44
    v_exp_f32 v45, v45
    v_smfmac_f32_32x32x32_bf16 v[92:107], v[124:127], v[68:75], v0
    v_exp_f32 v46, v46
    v_exp_f32 v47, v47
    v_exp_f32 v48, v48
    v_mfma_f32_32x32x16_bf16 v[60:75], v[112:115], v[8:11], v[28:43]
    ds_read_b128 v[112:115], v2 offset:63488
    s_mov_b64 exec, s[72:73]
    ds_read_b128 v[116:119], v3 offset:61440
    ds_read_b128 v[124:127], v3 offset:61952
    s_mov_b64 exec, -1
    v_exp_f32 v49, v49
    v_exp_f32 v50, v50
    v_exp_f32 v51, v51
    v_exp_f32 v52, v52
    v_exp_f32 v53, v53
    s_waitcnt lgkmcnt(3)
    v_smfmac_f32_32x32x32_bf16 v[76:91], v[120:123], v[44:51], v0
    v_exp_f32 v54, v54
    v_exp_f32 v55, v55
    v_exp_f32 v56, v56
    s_lshl_b32 s78, s64, 12
    s_add_u32 m0, s78, 1024
    s_mov_b32 s79, 212992
    buffer_load_dwordx4 v134, s[52:55], s79 offen lds
    v_exp_f32 v57, v57
    v_exp_f32 v58, v58
    v_exp_f32 v59, v59
    v_exp_f32 v60, v60
    v_exp_f32 v61, v61
    v_smfmac_f32_32x32x32_bf16 v[76:91], v[128:131], v[52:59], v0
    v_exp_f32 v62, v62
    v_exp_f32 v63, v63
    v_exp_f32 v64, v64
    v_mfma_f32_32x32x16_bf16 v[44:59], v[108:111], v[4:7], v[12:27]
    v_exp_f32 v65, v65
    v_exp_f32 v66, v66
    v_exp_f32 v67, v67
    s_waitcnt vmcnt(2)
    ds_read_b64_tr_b16 v[180:181], v135 offset:2048
    ds_read_b64_tr_b16 v[182:183], v135 offset:2560
    v_exp_f32 v68, v68
    v_exp_f32 v69, v69
    v_smfmac_f32_32x32x32_bf16 v[92:107], v[120:123], v[60:67], v0
    v_exp_f32 v70, v70
    v_exp_f32 v71, v71
    v_exp_f32 v72, v72
    v_exp_f32 v73, v73
    v_exp_f32 v74, v74
    v_exp_f32 v75, v75
    s_cmp_eq_u32 s74, 1
    s_cbranch_scc0 L_sy4_done
    s_cmp_ge_u32 s64, 4
    s_cbranch_scc0 L_sy4_spin
    v_mov_b32 v254, 1
    s_mov_b64 exec, 1
    ds_add_u32 v253, v254 offset:31744
    s_mov_b64 exec, -1
L_sy4_spin:
    ds_read_b32 v254, v253 offset:31744
    s_waitcnt lgkmcnt(0)
    v_readfirstlane_b32 s78, v254
    s_cmp_ge_u32 s78, 16
    s_cbranch_scc0 L_sy4_spin
L_sy4_done:
    v_exp_f32 v44, v44
    v_exp_f32 v45, v45
    v_smfmac_f32_32x32x32_bf16 v[92:107], v[128:131], v[68:75], v0
    v_exp_f32 v46, v46
    v_exp_f32 v47, v47
    v_exp_f32 v48, v48
    v_mfma_f32_32x32x16_bf16 v[60:75], v[108:111], v[8:11], v[28:43]
    ds_read_b128 v[108:111], v132 offset:0
    s_mov_b64 exec, s[72:73]
    ds_read_b128 v[120:123], v3 offset:63488
    ds_read_b128 v[128:131], v3 offset:64000
    s_mov_b64 exec, -1
    v_exp_f32 v49, v49
    v_exp_f32 v50, v50
    v_exp_f32 v51, v51
    v_exp_f32 v52, v52
    v_exp_f32 v53, v53
    s_waitcnt lgkmcnt(3)
    v_smfmac_f32_32x32x32_bf16 v[76:91], v[116:119], v[44:51], v0
    v_exp_f32 v54, v54
    v_exp_f32 v55, v55
    v_exp_f32 v56, v56
    s_lshl_b32 s78, s64, 12
    s_add_u32 m0, s78, 2048
    s_mov_b32 s79, 229376
    buffer_load_dwordx4 v134, s[52:55], s79 offen lds
    v_exp_f32 v57, v57
    v_exp_f32 v58, v58
    v_exp_f32 v59, v59
    v_exp_f32 v60, v60
    v_exp_f32 v61, v61
    v_smfmac_f32_32x32x32_bf16 v[76:91], v[124:127], v[52:59], v0
    v_exp_f32 v62, v62
    v_exp_f32 v63, v63
    v_exp_f32 v64, v64
    v_mfma_f32_32x32x16_bf16 v[44:59], v[112:115], v[4:7], v[12:27]
    v_exp_f32 v65, v65
    v_exp_f32 v66, v66
    v_exp_f32 v67, v67
    s_waitcnt vmcnt(2)
    ds_read_b64_tr_b16 v[184:185], v135 offset:0
    ds_read_b64_tr_b16 v[186:187], v135 offset:512
    v_exp_f32 v68, v68
    v_exp_f32 v69, v69
    v_smfmac_f32_32x32x32_bf16 v[92:107], v[116:119], v[60:67], v0
    v_exp_f32 v70, v70
    v_exp_f32 v71, v71
    v_exp_f32 v72, v72
    v_exp_f32 v73, v73
    v_exp_f32 v74, v74
    v_exp_f32 v75, v75
    v_exp_f32 v44, v44
    v_exp_f32 v45, v45
    v_smfmac_f32_32x32x32_bf16 v[92:107], v[124:127], v[68:75], v0
    v_exp_f32 v46, v46
    v_exp_f32 v47, v47
    v_exp_f32 v48, v48
    v_mfma_f32_32x32x16_bf16 v[60:75], v[112:115], v[8:11], v[28:43]
    ds_read_b128 v[112:115], v132 offset:2048
    s_mov_b64 exec, s[72:73]
    ds_read_b128 v[116:119], v133 offset:0
    ds_read_b128 v[124:127], v133 offset:512
    s_mov_b64 exec, -1
    v_exp_f32 v49, v49
    v_exp_f32 v50, v50
    v_exp_f32 v51, v51
    v_exp_f32 v52, v52
    v_exp_f32 v53, v53
    s_waitcnt lgkmcnt(3)
    v_smfmac_f32_32x32x32_bf16 v[76:91], v[120:123], v[44:51], v0
    v_exp_f32 v54, v54
    v_exp_f32 v55, v55
    v_exp_f32 v56, v56
    s_lshl_b32 s78, s64, 12
    s_add_u32 m0, s78, 0
    s_mov_b32 s79, 245760
    buffer_load_dwordx4 v134, s[52:55], s79 offen lds
    v_exp_f32 v57, v57
    v_exp_f32 v58, v58
    v_exp_f32 v59, v59
    v_exp_f32 v60, v60
    v_exp_f32 v61, v61
    v_smfmac_f32_32x32x32_bf16 v[76:91], v[128:131], v[52:59], v0
    v_exp_f32 v62, v62
    v_exp_f32 v63, v63
    v_exp_f32 v64, v64
    v_mfma_f32_32x32x16_bf16 v[44:59], v[108:111], v[4:7], v[12:27]
    v_exp_f32 v65, v65
    v_exp_f32 v66, v66
    v_exp_f32 v67, v67
    s_waitcnt vmcnt(2)
    ds_read_b64_tr_b16 v[188:189], v135 offset:1024
    ds_read_b64_tr_b16 v[190:191], v135 offset:1536
    v_exp_f32 v68, v68
    v_exp_f32 v69, v69
    v_smfmac_f32_32x32x32_bf16 v[92:107], v[120:123], v[60:67], v0
    v_exp_f32 v70, v70
    v_exp_f32 v71, v71
    v_exp_f32 v72, v72
    v_exp_f32 v73, v73
    v_exp_f32 v74, v74
    v_exp_f32 v75, v75
    v_exp_f32 v44, v44
    v_exp_f32 v45, v45
    v_smfmac_f32_32x32x32_bf16 v[92:107], v[128:131], v[68:75], v0
    v_exp_f32 v46, v46
    v_exp_f32 v47, v47
    v_exp_f32 v48, v48
    v_mfma_f32_32x32x16_bf16 v[60:75], v[108:111], v[8:11], v[28:43]
    ds_read_b128 v[108:111], v132 offset:4096
    s_mov_b64 exec, s[72:73]
    ds_read_b128 v[120:123], v133 offset:2048
    ds_read_b128 v[128:131], v133 offset:2560
    s_mov_b64 exec, -1
    v_exp_f32 v49, v49
    v_exp_f32 v50, v50
    v_exp_f32 v51, v51
    v_exp_f32 v52, v52
    v_exp_f32 v53, v53
    s_waitcnt lgkmcnt(3)
    v_smfmac_f32_32x32x32_bf16 v[76:91], v[116:119], v[44:51], v0
    v_exp_f32 v54, v54
    v_exp_f32 v55, v55
    v_exp_f32 v56, v56
    s_lshl_b32 s78, s64, 12
    s_add_u32 m0, s78, 1024
    s_mov_b32 s79, 262144
    buffer_load_dwordx4 v134, s[52:55], s79 offen lds
    v_exp_f32 v57, v57
    v_exp_f32 v58, v58
    v_exp_f32 v59, v59
    v_exp_f32 v60, v60
    v_exp_f32 v61, v61
    v_smfmac_f32_32x32x32_bf16 v[76:91], v[124:127], v[52:59], v0
    v_exp_f32 v62, v62
    v_exp_f32 v63, v63
    v_exp_f32 v64, v64
    v_mfma_f32_32x32x16_bf16 v[44:59], v[112:115], v[4:7], v[12:27]
    v_exp_f32 v65, v65
    v_exp_f32 v66, v66
    v_exp_f32 v67, v67
    s_waitcnt vmcnt(2)
    ds_read_b64_tr_b16 v[192:193], v135 offset:2048
    ds_read_b64_tr_b16 v[194:195], v135 offset:2560
    v_exp_f32 v68, v68
    v_exp_f32 v69, v69
    v_smfmac_f32_32x32x32_bf16 v[92:107], v[116:119], v[60:67], v0
    v_exp_f32 v70, v70
    v_exp_f32 v71, v71
    v_exp_f32 v72, v72
    v_exp_f32 v73, v73
    v_exp_f32 v74, v74
    v_exp_f32 v75, v75
    v_exp_f32 v44, v44
    v_exp_f32 v45, v45
    v_smfmac_f32_32x32x32_bf16 v[92:107], v[124:127], v[68:75], v0
    v_exp_f32 v46, v46
    v_exp_f32 v47, v47
    v_exp_f32 v48, v48
    v_mfma_f32_32x32x16_bf16 v[60:75], v[112:115], v[8:11], v[28:43]
    ds_read_b128 v[112:115], v132 offset:6144
    s_mov_b64 exec, s[72:73]
    ds_read_b128 v[116:119], v133 offset:4096
    ds_read_b128 v[124:127], v133 offset:4608
    s_mov_b64 exec, -1
    v_exp_f32 v49, v49
    v_exp_f32 v50, v50
    v_exp_f32 v51, v51
    v_exp_f32 v52, v52
    v_exp_f32 v53, v53
    s_waitcnt lgkmcnt(3)
    v_smfmac_f32_32x32x32_bf16 v[76:91], v[120:123], v[44:51], v0
    v_exp_f32 v54, v54
    v_exp_f32 v55, v55
    v_exp_f32 v56, v56
    s_lshl_b32 s78, s64, 12
    s_add_u32 m0, s78, 2048
    s_mov_b32 s79, 278528
    buffer_load_dwordx4 v134, s[52:55], s79 offen lds
    v_exp_f32 v57, v57
    v_exp_f32 v58, v58
    v_exp_f32 v59, v59
    v_exp_f32 v60, v60
    v_exp_f32 v61, v61
    v_smfmac_f32_32x32x32_bf16 v[76:91], v[128:131], v[52:59], v0
    v_exp_f32 v62, v62
    v_exp_f32 v63, v63
    v_exp_f32 v64, v64
    v_mfma_f32_32x32x16_bf16 v[44:59], v[108:111], v[4:7], v[12:27]
    v_exp_f32 v65, v65
    v_exp_f32 v66, v66
    v_exp_f32 v67, v67
    s_waitcnt vmcnt(2)
    ds_read_b64_tr_b16 v[196:197], v135 offset:0
    ds_read_b64_tr_b16 v[198:199], v135 offset:512
    v_exp_f32 v68, v68
    v_exp_f32 v69, v69
    v_smfmac_f32_32x32x32_bf16 v[92:107], v[120:123], v[60:67], v0
    v_exp_f32 v70, v70
    v_exp_f32 v71, v71
    v_exp_f32 v72, v72
    v_exp_f32 v73, v73
    v_exp_f32 v74, v74
    v_exp_f32 v75, v75
    v_exp_f32 v44, v44
    v_exp_f32 v45, v45
    v_smfmac_f32_32x32x32_bf16 v[92:107], v[128:131], v[68:75], v0
    v_exp_f32 v46, v46
    v_exp_f32 v47, v47
    v_exp_f32 v48, v48
    v_mfma_f32_32x32x16_bf16 v[60:75], v[108:111], v[8:11], v[28:43]
    ds_read_b128 v[108:111], v132 offset:8192
    s_mov_b64 exec, s[72:73]
    ds_read_b128 v[120:123], v133 offset:6144
    ds_read_b128 v[128:131], v133 offset:6656
    s_mov_b64 exec, -1
    v_exp_f32 v49, v49
    v_exp_f32 v50, v50
    v_exp_f32 v51, v51
    v_exp_f32 v52, v52
    v_exp_f32 v53, v53
    s_waitcnt lgkmcnt(3)
    v_smfmac_f32_32x32x32_bf16 v[76:91], v[116:119], v[44:51], v0
    v_exp_f32 v54, v54
    v_exp_f32 v55, v55
    v_exp_f32 v56, v56
    s_lshl_b32 s78, s64, 12
    s_add_u32 m0, s78, 0
    s_mov_b32 s79, 294912
    buffer_load_dwordx4 v134, s[52:55], s79 offen lds
    v_exp_f32 v57, v57
    v_exp_f32 v58, v58
    v_exp_f32 v59, v59
    v_exp_f32 v60, v60
    v_exp_f32 v61, v61
    v_smfmac_f32_32x32x32_bf16 v[76:91], v[124:127], v[52:59], v0
    v_exp_f32 v62, v62
    v_exp_f32 v63, v63
    v_exp_f32 v64, v64
    v_mfma_f32_32x32x16_bf16 v[44:59], v[112:115], v[4:7], v[12:27]
    v_exp_f32 v65, v65
    v_exp_f32 v66, v66
    v_exp_f32 v67, v67
    s_waitcnt vmcnt(2)
    ds_read_b64_tr_b16 v[200:201], v135 offset:1024
    ds_read_b64_tr_b16 v[202:203], v135 offset:1536
    v_exp_f32 v68, v68
    v_exp_f32 v69, v69
    v_smfmac_f32_32x32x32_bf16 v[92:107], v[116:119], v[60:67], v0
    v_exp_f32 v70, v70
    v_exp_f32 v71, v71
    v_exp_f32 v72, v72
    v_exp_f32 v73, v73
    v_exp_f32 v74, v74
    v_exp_f32 v75, v75
    v_exp_f32 v44, v44
    v_exp_f32 v45, v45
    v_smfmac_f32_32x32x32_bf16 v[92:107], v[124:127], v[68:75], v0
    v_exp_f32 v46, v46
    v_exp_f32 v47, v47
    v_exp_f32 v48, v48
    v_mfma_f32_32x32x16_bf16 v[60:75], v[112:115], v[8:11], v[28:43]
    ds_read_b128 v[112:115], v132 offset:10240
    s_mov_b64 exec, s[72:73]
    ds_read_b128 v[116:119], v133 offset:8192
    ds_read_b128 v[124:127], v133 offset:8704
    s_mov_b64 exec, -1
    v_exp_f32 v49, v49
    v_exp_f32 v50, v50
    v_exp_f32 v51, v51
    v_exp_f32 v52, v52
    v_exp_f32 v53, v53
    s_waitcnt lgkmcnt(3)
    v_smfmac_f32_32x32x32_bf16 v[76:91], v[120:123], v[44:51], v0
    v_exp_f32 v54, v54
    v_exp_f32 v55, v55
    v_exp_f32 v56, v56
    s_lshl_b32 s78, s64, 12
    s_add_u32 m0, s78, 1024
    s_mov_b32 s79, 311296
    buffer_load_dwordx4 v134, s[52:55], s79 offen lds
    v_exp_f32 v57, v57
    v_exp_f32 v58, v58
    v_exp_f32 v59, v59
    v_exp_f32 v60, v60
    v_exp_f32 v61, v61
    v_smfmac_f32_32x32x32_bf16 v[76:91], v[128:131], v[52:59], v0
    v_exp_f32 v62, v62
    v_exp_f32 v63, v63
    v_exp_f32 v64, v64
    v_mfma_f32_32x32x16_bf16 v[44:59], v[108:111], v[4:7], v[12:27]
    v_exp_f32 v65, v65
    v_exp_f32 v66, v66
    v_exp_f32 v67, v67
    s_waitcnt vmcnt(2)
    ds_read_b64_tr_b16 v[204:205], v135 offset:2048
    ds_read_b64_tr_b16 v[206:207], v135 offset:2560
    v_exp_f32 v68, v68
    v_exp_f32 v69, v69
    v_smfmac_f32_32x32x32_bf16 v[92:107], v[120:123], v[60:67], v0
    v_exp_f32 v70, v70
    v_exp_f32 v71, v71
    v_exp_f32 v72, v72
    v_exp_f32 v73, v73
    v_exp_f32 v74, v74
    v_exp_f32 v75, v75
    v_exp_f32 v44, v44
    v_exp_f32 v45, v45
    v_smfmac_f32_32x32x32_bf16 v[92:107], v[128:131], v[68:75], v0
    v_exp_f32 v46, v46
    v_exp_f32 v47, v47
    v_exp_f32 v48, v48
    v_mfma_f32_32x32x16_bf16 v[60:75], v[108:111], v[8:11], v[28:43]
    ds_read_b128 v[108:111], v132 offset:12288
    s_mov_b64 exec, s[72:73]
    ds_read_b128 v[120:123], v133 offset:10240
    ds_read_b128 v[128:131], v133 offset:10752
    s_mov_b64 exec, -1
    v_exp_f32 v49, v49
    v_exp_f32 v50, v50
    v_exp_f32 v51, v51
    v_exp_f32 v52, v52
    v_exp_f32 v53, v53
    s_waitcnt lgkmcnt(3)
    v_smfmac_f32_32x32x32_bf16 v[76:91], v[116:119], v[44:51], v0
    v_exp_f32 v54, v54
    v_exp_f32 v55, v55
    v_exp_f32 v56, v56
    s_lshl_b32 s78, s64, 12
    s_add_u32 m0, s78, 2048
    s_mov_b32 s79, 327680
    buffer_load_dwordx4 v134, s[52:55], s79 offen lds
    v_exp_f32 v57, v57
    v_exp_f32 v58, v58
    v_exp_f32 v59, v59
    v_exp_f32 v60, v60
    v_exp_f32 v61, v61
    v_smfmac_f32_32x32x32_bf16 v[76:91], v[124:127], v[52:59], v0
    v_exp_f32 v62, v62
    v_exp_f32 v63, v63
    v_exp_f32 v64, v64
    v_mfma_f32_32x32x16_bf16 v[44:59], v[112:115], v[4:7], v[12:27]
    v_exp_f32 v65, v65
    v_exp_f32 v66, v66
    v_exp_f32 v67, v67
    s_waitcnt vmcnt(2)
    ds_read_b64_tr_b16 v[208:209], v135 offset:0
    ds_read_b64_tr_b16 v[210:211], v135 offset:512
    v_exp_f32 v68, v68
    v_exp_f32 v69, v69
    v_smfmac_f32_32x32x32_bf16 v[92:107], v[116:119], v[60:67], v0
    v_exp_f32 v70, v70
    v_exp_f32 v71, v71
    v_exp_f32 v72, v72
    v_exp_f32 v73, v73
    v_exp_f32 v74, v74
    v_exp_f32 v75, v75
    v_exp_f32 v44, v44
    v_exp_f32 v45, v45
    v_smfmac_f32_32x32x32_bf16 v[92:107], v[124:127], v[68:75], v0
    v_exp_f32 v46, v46
    v_exp_f32 v47, v47
    v_exp_f32 v48, v48
    v_mfma_f32_32x32x16_bf16 v[60:75], v[112:115], v[8:11], v[28:43]
    ds_read_b128 v[112:115], v132 offset:14336
    s_mov_b64 exec, s[72:73]
    ds_read_b128 v[116:119], v133 offset:12288
    ds_read_b128 v[124:127], v133 offset:12800
    s_mov_b64 exec, -1
    v_exp_f32 v49, v49
    v_exp_f32 v50, v50
    v_exp_f32 v51, v51
    v_exp_f32 v52, v52
    v_exp_f32 v53, v53
    s_waitcnt lgkmcnt(3)
    v_smfmac_f32_32x32x32_bf16 v[76:91], v[120:123], v[44:51], v0
    v_exp_f32 v54, v54
    v_exp_f32 v55, v55
    v_exp_f32 v56, v56
    s_lshl_b32 s78, s64, 12
    s_add_u32 m0, s78, 0
    s_mov_b32 s79, 344064
    buffer_load_dwordx4 v134, s[52:55], s79 offen lds
    v_exp_f32 v57, v57
    v_exp_f32 v58, v58
    v_exp_f32 v59, v59
    v_exp_f32 v60, v60
    v_exp_f32 v61, v61
    v_smfmac_f32_32x32x32_bf16 v[76:91], v[128:131], v[52:59], v0
    v_exp_f32 v62, v62
    v_exp_f32 v63, v63
    v_exp_f32 v64, v64
    v_mfma_f32_32x32x16_bf16 v[44:59], v[108:111], v[4:7], v[12:27]
    v_exp_f32 v65, v65
    v_exp_f32 v66, v66
    v_exp_f32 v67, v67
    s_waitcnt vmcnt(2)
    ds_read_b64_tr_b16 v[212:213], v135 offset:1024
    ds_read_b64_tr_b16 v[214:215], v135 offset:1536
    v_exp_f32 v68, v68
    v_exp_f32 v69, v69
    v_smfmac_f32_32x32x32_bf16 v[92:107], v[120:123], v[60:67], v0
    v_exp_f32 v70, v70
    v_exp_f32 v71, v71
    v_exp_f32 v72, v72
    v_exp_f32 v73, v73
    v_exp_f32 v74, v74
    v_exp_f32 v75, v75
    v_exp_f32 v44, v44
    v_exp_f32 v45, v45
    v_smfmac_f32_32x32x32_bf16 v[92:107], v[128:131], v[68:75], v0
    v_exp_f32 v46, v46
    v_exp_f32 v47, v47
    v_exp_f32 v48, v48
    v_mfma_f32_32x32x16_bf16 v[60:75], v[108:111], v[8:11], v[28:43]
    ds_read_b128 v[108:111], v132 offset:16384
    s_mov_b64 exec, s[72:73]
    ds_read_b128 v[120:123], v133 offset:14336
    ds_read_b128 v[128:131], v133 offset:14848
    s_mov_b64 exec, -1
    v_exp_f32 v49, v49
    v_exp_f32 v50, v50
    v_exp_f32 v51, v51
    v_exp_f32 v52, v52
    v_exp_f32 v53, v53
    s_waitcnt lgkmcnt(3)
    v_smfmac_f32_32x32x32_bf16 v[76:91], v[116:119], v[44:51], v0
    v_exp_f32 v54, v54
    v_exp_f32 v55, v55
    v_exp_f32 v56, v56
    s_lshl_b32 s78, s64, 12
    s_add_u32 m0, s78, 1024
    s_mov_b32 s79, 360448
    buffer_load_dwordx4 v134, s[52:55], s79 offen lds
    v_exp_f32 v57, v57
    v_exp_f32 v58, v58
    v_exp_f32 v59, v59
    v_exp_f32 v60, v60
    v_exp_f32 v61, v61
    v_smfmac_f32_32x32x32_bf16 v[76:91], v[124:127], v[52:59], v0
    v_exp_f32 v62, v62
    v_exp_f32 v63, v63
    v_exp_f32 v64, v64
    v_mfma_f32_32x32x16_bf16 v[44:59], v[112:115], v[4:7], v[12:27]
    v_exp_f32 v65, v65
    v_exp_f32 v66, v66
    v_exp_f32 v67, v67
    s_waitcnt vmcnt(2)
    ds_read_b64_tr_b16 v[216:217], v135 offset:2048
    ds_read_b64_tr_b16 v[218:219], v135 offset:2560
    v_exp_f32 v68, v68
    v_exp_f32 v69, v69
    v_smfmac_f32_32x32x32_bf16 v[92:107], v[116:119], v[60:67], v0
    v_exp_f32 v70, v70
    v_exp_f32 v71, v71
    v_exp_f32 v72, v72
    v_exp_f32 v73, v73
    v_exp_f32 v74, v74
    v_exp_f32 v75, v75
    v_exp_f32 v44, v44
    v_exp_f32 v45, v45
    v_smfmac_f32_32x32x32_bf16 v[92:107], v[124:127], v[68:75], v0
    v_exp_f32 v46, v46
    v_exp_f32 v47, v47
    v_exp_f32 v48, v48
    v_mfma_f32_32x32x16_bf16 v[60:75], v[112:115], v[8:11], v[28:43]
    ds_read_b128 v[112:115], v132 offset:18432
    s_mov_b64 exec, s[72:73]
    ds_read_b128 v[116:119], v133 offset:16384
    ds_read_b128 v[124:127], v133 offset:16896
    s_mov_b64 exec, -1
    v_exp_f32 v49, v49
    v_exp_f32 v50, v50
    v_exp_f32 v51, v51
    v_exp_f32 v52, v52
    v_exp_f32 v53, v53
    s_waitcnt lgkmcnt(3)
    v_smfmac_f32_32x32x32_bf16 v[76:91], v[120:123], v[44:51], v0
    v_exp_f32 v54, v54
    v_exp_f32 v55, v55
    v_exp_f32 v56, v56
    s_lshl_b32 s78, s64, 12
    s_add_u32 m0, s78, 2048
    s_mov_b32 s79, 376832
    buffer_load_dwordx4 v134, s[52:55], s79 offen lds
    v_exp_f32 v57, v57
    v_exp_f32 v58, v58
    v_exp_f32 v59, v59
    v_exp_f32 v60, v60
    v_exp_f32 v61, v61
    v_smfmac_f32_32x32x32_bf16 v[76:91], v[128:131], v[52:59], v0
    v_exp_f32 v62, v62
    v_exp_f32 v63, v63
    v_exp_f32 v64, v64
    v_mfma_f32_32x32x16_bf16 v[44:59], v[108:111], v[4:7], v[12:27]
    v_exp_f32 v65, v65
    v_exp_f32 v66, v66
    v_exp_f32 v67, v67
    s_waitcnt vmcnt(2)
    ds_read_b64_tr_b16 v[220:221], v135 offset:0
    ds_read_b64_tr_b16 v[222:223], v135 offset:512
    v_exp_f32 v68, v68
    v_exp_f32 v69, v69
    v_smfmac_f32_32x32x32_bf16 v[92:107], v[120:123], v[60:67], v0
    v_exp_f32 v70, v70
    v_exp_f32 v71, v71
    v_exp_f32 v72, v72
    v_exp_f32 v73, v73
    v_exp_f32 v74, v74
    v_exp_f32 v75, v75
    v_exp_f32 v44, v44
    v_exp_f32 v45, v45
    v_smfmac_f32_32x32x32_bf16 v[92:107], v[128:131], v[68:75], v0
    v_exp_f32 v46, v46
    v_exp_f32 v47, v47
    v_exp_f32 v48, v48
    v_mfma_f32_32x32x16_bf16 v[60:75], v[108:111], v[8:11], v[28:43]
    ds_read_b128 v[108:111], v132 offset:20480
    s_mov_b64 exec, s[72:73]
    ds_read_b128 v[120:123], v133 offset:18432
    ds_read_b128 v[128:131], v133 offset:18944
    s_mov_b64 exec, -1
    v_exp_f32 v49, v49
    v_exp_f32 v50, v50
    v_exp_f32 v51, v51
    v_exp_f32 v52, v52
    v_exp_f32 v53, v53
    s_waitcnt lgkmcnt(3)
    v_smfmac_f32_32x32x32_bf16 v[76:91], v[116:119], v[44:51], v0
    v_exp_f32 v54, v54
    v_exp_f32 v55, v55
    v_exp_f32 v56, v56
    s_lshl_b32 s78, s64, 12
    s_add_u32 m0, s78, 0
    s_mov_b32 s79, 393216
    buffer_load_dwordx4 v134, s[52:55], s79 offen lds
    v_exp_f32 v57, v57
    v_exp_f32 v58, v58
    v_exp_f32 v59, v59
    v_exp_f32 v60, v60
    v_exp_f32 v61, v61
    v_smfmac_f32_32x32x32_bf16 v[76:91], v[124:127], v[52:59], v0
    v_exp_f32 v62, v62
    v_exp_f32 v63, v63
    v_exp_f32 v64, v64
    v_mfma_f32_32x32x16_bf16 v[44:59], v[112:115], v[4:7], v[12:27]
    v_exp_f32 v65, v65
    v_exp_f32 v66, v66
    v_exp_f32 v67, v67
    s_waitcnt vmcnt(2)
    ds_read_b64_tr_b16 v[224:225], v135 offset:1024
    ds_read_b64_tr_b16 v[226:227], v135 offset:1536
    v_exp_f32 v68, v68
    v_exp_f32 v69, v69
    v_smfmac_f32_32x32x32_bf16 v[92:107], v[116:119], v[60:67], v0
    v_exp_f32 v70, v70
    v_exp_f32 v71, v71
    v_exp_f32 v72, v72
    v_exp_f32 v73, v73
    v_exp_f32 v74, v74
    v_exp_f32 v75, v75
    v_exp_f32 v44, v44
    v_exp_f32 v45, v45
    v_smfmac_f32_32x32x32_bf16 v[92:107], v[124:127], v[68:75], v0
    v_exp_f32 v46, v46
    v_exp_f32 v47, v47
    v_exp_f32 v48, v48
    v_mfma_f32_32x32x16_bf16 v[60:75], v[112:115], v[8:11], v[28:43]
    ds_read_b128 v[112:115], v132 offset:22528
    s_mov_b64 exec, s[72:73]
    ds_read_b128 v[116:119], v133 offset:20480
    ds_read_b128 v[124:127], v133 offset:20992
    s_mov_b64 exec, -1
    v_exp_f32 v49, v49
    v_exp_f32 v50, v50
    v_exp_f32 v51, v51
    v_exp_f32 v52, v52
    v_exp_f32 v53, v53
    s_waitcnt lgkmcnt(3)
    v_smfmac_f32_32x32x32_bf16 v[76:91], v[120:123], v[44:51], v0
    v_exp_f32 v54, v54
    v_exp_f32 v55, v55
    v_exp_f32 v56, v56
    s_lshl_b32 s78, s64, 12
    s_add_u32 m0, s78, 1024
    s_mov_b32 s79, 409600
    buffer_load_dwordx4 v134, s[52:55], s79 offen lds
    v_exp_f32 v57, v57
    v_exp_f32 v58, v58
    v_exp_f32 v59, v59
    v_exp_f32 v60, v60
    v_exp_f32 v61, v61
    v_smfmac_f32_32x32x32_bf16 v[76:91], v[128:131], v[52:59], v0
    v_exp_f32 v62, v62
    v_exp_f32 v63, v63
    v_exp_f32 v64, v64
    v_mfma_f32_32x32x16_bf16 v[44:59], v[108:111], v[4:7], v[12:27]
    v_exp_f32 v65, v65
    v_exp_f32 v66, v66
    v_exp_f32 v67, v67
    s_waitcnt vmcnt(2)
    ds_read_b64_tr_b16 v[228:229], v135 offset:2048
    ds_read_b64_tr_b16 v[230:231], v135 offset:2560
    v_exp_f32 v68, v68
    v_exp_f32 v69, v69
    v_smfmac_f32_32x32x32_bf16 v[92:107], v[120:123], v[60:67], v0
    v_exp_f32 v70, v70
    v_exp_f32 v71, v71
    v_exp_f32 v72, v72
    v_exp_f32 v73, v73
    v_exp_f32 v74, v74
    v_exp_f32 v75, v75
    v_exp_f32 v44, v44
    v_exp_f32 v45, v45
    v_smfmac_f32_32x32x32_bf16 v[92:107], v[128:131], v[68:75], v0
    v_exp_f32 v46, v46
    v_exp_f32 v47, v47
    v_exp_f32 v48, v48
    v_mfma_f32_32x32x16_bf16 v[60:75], v[108:111], v[8:11], v[28:43]
    ds_read_b128 v[108:111], v132 offset:24576
    s_mov_b64 exec, s[72:73]
    ds_read_b128 v[120:123], v133 offset:22528
    ds_read_b128 v[128:131], v133 offset:23040
    s_mov_b64 exec, -1
    v_exp_f32 v49, v49
    v_exp_f32 v50, v50
    v_exp_f32 v51, v51
    v_exp_f32 v52, v52
    v_exp_f32 v53, v53
    s_waitcnt lgkmcnt(3)
    v_smfmac_f32_32x32x32_bf16 v[76:91], v[116:119], v[44:51], v0
    v_exp_f32 v54, v54
    v_exp_f32 v55, v55
    v_exp_f32 v56, v56
    s_lshl_b32 s78, s64, 12
    s_add_u32 m0, s78, 2048
    s_mov_b32 s79, 425984
    buffer_load_dwordx4 v134, s[52:55], s79 offen lds
    v_exp_f32 v57, v57
    v_exp_f32 v58, v58
    v_exp_f32 v59, v59
    v_exp_f32 v60, v60
    v_exp_f32 v61, v61
    v_smfmac_f32_32x32x32_bf16 v[76:91], v[124:127], v[52:59], v0
    v_exp_f32 v62, v62
    v_exp_f32 v63, v63
    v_exp_f32 v64, v64
    v_mfma_f32_32x32x16_bf16 v[44:59], v[112:115], v[4:7], v[12:27]
    v_exp_f32 v65, v65
    v_exp_f32 v66, v66
    v_exp_f32 v67, v67
    s_waitcnt vmcnt(2)
    ds_read_b64_tr_b16 v[232:233], v135 offset:0
    ds_read_b64_tr_b16 v[234:235], v135 offset:512
    v_exp_f32 v68, v68
    v_exp_f32 v69, v69
    v_smfmac_f32_32x32x32_bf16 v[92:107], v[116:119], v[60:67], v0
    v_exp_f32 v70, v70
    v_exp_f32 v71, v71
    v_exp_f32 v72, v72
    v_exp_f32 v73, v73
    v_exp_f32 v74, v74
    v_exp_f32 v75, v75
    v_exp_f32 v44, v44
    v_exp_f32 v45, v45
    v_smfmac_f32_32x32x32_bf16 v[92:107], v[124:127], v[68:75], v0
    v_exp_f32 v46, v46
    v_exp_f32 v47, v47
    v_exp_f32 v48, v48
    v_mfma_f32_32x32x16_bf16 v[60:75], v[112:115], v[8:11], v[28:43]
    ds_read_b128 v[112:115], v132 offset:26624
    s_mov_b64 exec, s[72:73]
    ds_read_b128 v[116:119], v133 offset:24576
    ds_read_b128 v[124:127], v133 offset:25088
    s_mov_b64 exec, -1
    v_exp_f32 v49, v49
    v_exp_f32 v50, v50
    v_exp_f32 v51, v51
    v_exp_f32 v52, v52
    v_exp_f32 v53, v53
    s_waitcnt lgkmcnt(3)
    v_smfmac_f32_32x32x32_bf16 v[76:91], v[120:123], v[44:51], v0
    v_exp_f32 v54, v54
    v_exp_f32 v55, v55
    v_exp_f32 v56, v56
    s_lshl_b32 s78, s64, 12
    s_add_u32 m0, s78, 0
    s_mov_b32 s79, 442368
    buffer_load_dwordx4 v134, s[52:55], s79 offen lds
    v_exp_f32 v57, v57
    v_exp_f32 v58, v58
    v_exp_f32 v59, v59
    v_exp_f32 v60, v60
    v_exp_f32 v61, v61
    v_smfmac_f32_32x32x32_bf16 v[76:91], v[128:131], v[52:59], v0
    v_exp_f32 v62, v62
    v_exp_f32 v63, v63
    v_exp_f32 v64, v64
    v_mfma_f32_32x32x16_bf16 v[44:59], v[108:111], v[4:7], v[12:27]
    v_exp_f32 v65, v65
    v_exp_f32 v66, v66
    v_exp_f32 v67, v67
    s_waitcnt vmcnt(2)
    ds_read_b64_tr_b16 v[236:237], v135 offset:1024
    ds_read_b64_tr_b16 v[238:239], v135 offset:1536
    v_exp_f32 v68, v68
    v_exp_f32 v69, v69
    v_smfmac_f32_32x32x32_bf16 v[92:107], v[120:123], v[60:67], v0
    v_exp_f32 v70, v70
    v_exp_f32 v71, v71
    v_exp_f32 v72, v72
    v_exp_f32 v73, v73
    v_exp_f32 v74, v74
    v_exp_f32 v75, v75
    v_exp_f32 v44, v44
    v_exp_f32 v45, v45
    v_smfmac_f32_32x32x32_bf16 v[92:107], v[128:131], v[68:75], v0
    v_exp_f32 v46, v46
    v_exp_f32 v47, v47
    v_exp_f32 v48, v48
    v_mfma_f32_32x32x16_bf16 v[60:75], v[108:111], v[8:11], v[28:43]
    ds_read_b128 v[108:111], v132 offset:28672
    s_mov_b64 exec, s[72:73]
    ds_read_b128 v[120:123], v133 offset:26624
    ds_read_b128 v[128:131], v133 offset:27136
    s_mov_b64 exec, -1
    v_exp_f32 v49, v49
    v_exp_f32 v50, v50
    v_exp_f32 v51, v51
    v_exp_f32 v52, v52
    v_exp_f32 v53, v53
    s_waitcnt lgkmcnt(3)
    v_smfmac_f32_32x32x32_bf16 v[76:91], v[116:119], v[44:51], v0
    v_exp_f32 v54, v54
    v_exp_f32 v55, v55
    v_exp_f32 v56, v56
    s_lshl_b32 s78, s64, 12
    s_add_u32 m0, s78, 1024
    s_mov_b32 s79, 458752
    buffer_load_dwordx4 v134, s[52:55], s79 offen lds
    v_exp_f32 v57, v57
    v_exp_f32 v58, v58
    v_exp_f32 v59, v59
    v_exp_f32 v60, v60
    v_exp_f32 v61, v61
    v_smfmac_f32_32x32x32_bf16 v[76:91], v[124:127], v[52:59], v0
    v_exp_f32 v62, v62
    v_exp_f32 v63, v63
    v_exp_f32 v64, v64
    v_mfma_f32_32x32x16_bf16 v[44:59], v[112:115], v[4:7], v[12:27]
    v_exp_f32 v65, v65
    v_exp_f32 v66, v66
    v_exp_f32 v67, v67
    s_waitcnt vmcnt(2)
    ds_read_b64_tr_b16 v[240:241], v135 offset:2048
    ds_read_b64_tr_b16 v[242:243], v135 offset:2560
    v_exp_f32 v68, v68
    v_exp_f32 v69, v69
    v_smfmac_f32_32x32x32_bf16 v[92:107], v[116:119], v[60:67], v0
    v_exp_f32 v70, v70
    v_exp_f32 v71, v71
    v_exp_f32 v72, v72
    v_exp_f32 v73, v73
    v_exp_f32 v74, v74
    v_exp_f32 v75, v75
    v_exp_f32 v44, v44
    v_exp_f32 v45, v45
    v_smfmac_f32_32x32x32_bf16 v[92:107], v[124:127], v[68:75], v0
    v_exp_f32 v46, v46
    v_exp_f32 v47, v47
    v_exp_f32 v48, v48
    v_mfma_f32_32x32x16_bf16 v[60:75], v[112:115], v[8:11], v[28:43]
    ds_read_b128 v[112:115], v132 offset:30720
    s_mov_b64 exec, s[72:73]
    ds_read_b128 v[116:119], v133 offset:28672
    ds_read_b128 v[124:127], v133 offset:29184
    s_mov_b64 exec, -1
    v_exp_f32 v49, v49
    v_exp_f32 v50, v50
    v_exp_f32 v51, v51
    v_exp_f32 v52, v52
    v_exp_f32 v53, v53
    s_waitcnt lgkmcnt(3)
    v_smfmac_f32_32x32x32_bf16 v[76:91], v[120:123], v[44:51], v0
    v_exp_f32 v54, v54
    v_exp_f32 v55, v55
    v_exp_f32 v56, v56
    v_exp_f32 v57, v57
    v_exp_f32 v58, v58
    v_exp_f32 v59, v59
    v_exp_f32 v60, v60
    v_exp_f32 v61, v61
    v_smfmac_f32_32x32x32_bf16 v[76:91], v[128:131], v[52:59], v0
    v_exp_f32 v62, v62
    v_exp_f32 v63, v63
    v_exp_f32 v64, v64
    v_mfma_f32_32x32x16_bf16 v[44:59], v[108:111], v[4:7], v[12:27]
    v_exp_f32 v65, v65
    v_exp_f32 v66, v66
    v_exp_f32 v67, v67
    s_waitcnt vmcnt(1)
    ds_read_b64_tr_b16 v[244:245], v135 offset:0
    ds_read_b64_tr_b16 v[246:247], v135 offset:512
    v_exp_f32 v68, v68
    v_exp_f32 v69, v69
    v_smfmac_f32_32x32x32_bf16 v[92:107], v[120:123], v[60:67], v0
    v_exp_f32 v70, v70
    v_exp_f32 v71, v71
    v_exp_f32 v72, v72
    v_exp_f32 v73, v73
    v_exp_f32 v74, v74
    v_exp_f32 v75, v75
    v_exp_f32 v44, v44
    v_exp_f32 v45, v45
    v_smfmac_f32_32x32x32_bf16 v[92:107], v[128:131], v[68:75], v0
    v_exp_f32 v46, v46
    v_exp_f32 v47, v47
    v_exp_f32 v48, v48
    v_mfma_f32_32x32x16_bf16 v[60:75], v[108:111], v[8:11], v[28:43]
    ds_read_b128 v[108:111], v132 offset:32768
    s_mov_b64 exec, s[72:73]
    ds_read_b128 v[120:123], v133 offset:30720
    ds_read_b128 v[128:131], v133 offset:31232
    s_mov_b64 exec, -1
    v_exp_f32 v49, v49
    v_exp_f32 v50, v50
    v_exp_f32 v51, v51
    v_exp_f32 v52, v52
    v_exp_f32 v53, v53
    s_waitcnt lgkmcnt(3)
    v_smfmac_f32_32x32x32_bf16 v[76:91], v[116:119], v[44:51], v0
    v_exp_f32 v54, v54
    v_exp_f32 v55, v55
    v_exp_f32 v56, v56
    v_exp_f32 v57, v57
    v_exp_f32 v58, v58
    v_exp_f32 v59, v59
    v_exp_f32 v60, v60
    v_exp_f32 v61, v61
    v_smfmac_f32_32x32x32_bf16 v[76:91], v[124:127], v[52:59], v0
    v_exp_f32 v62, v62
    v_exp_f32 v63, v63
    v_exp_f32 v64, v64
    v_mfma_f32_32x32x16_bf16 v[44:59], v[112:115], v[4:7], v[12:27]
    v_exp_f32 v65, v65
    v_exp_f32 v66, v66
    v_exp_f32 v67, v67
    s_waitcnt vmcnt(0)
    ds_read_b64_tr_b16 v[248:249], v135 offset:1024
    ds_read_b64_tr_b16 v[250:251], v135 offset:1536
    v_exp_f32 v68, v68
    v_exp_f32 v69, v69
    v_smfmac_f32_32x32x32_bf16 v[92:107], v[116:119], v[60:67], v0
    v_exp_f32 v70, v70
    v_exp_f32 v71, v71
    v_exp_f32 v72, v72
    v_exp_f32 v73, v73
    v_exp_f32 v74, v74
    v_exp_f32 v75, v75
    v_exp_f32 v44, v44
    v_exp_f32 v45, v45
    v_smfmac_f32_32x32x32_bf16 v[92:107], v[124:127], v[68:75], v0
    v_exp_f32 v46, v46
    v_exp_f32 v47, v47
    v_exp_f32 v48, v48
    v_mfma_f32_32x32x16_bf16 v[60:75], v[112:115], v[8:11], v[28:43]
    ds_read_b128 v[112:115], v132 offset:34816
    s_mov_b64 exec, s[72:73]
    ds_read_b128 v[116:119], v133 offset:32768
    ds_read_b128 v[124:127], v133 offset:33280
    s_mov_b64 exec, -1
    v_exp_f32 v49, v49
    v_exp_f32 v50, v50
    v_exp_f32 v51, v51
    v_exp_f32 v52, v52
    v_exp_f32 v53, v53
    s_waitcnt lgkmcnt(3)
    v_smfmac_f32_32x32x32_bf16 v[76:91], v[120:123], v[44:51], v0
    v_exp_f32 v54, v54
    v_exp_f32 v55, v55
    v_exp_f32 v56, v56
    v_exp_f32 v57, v57
    v_exp_f32 v58, v58
    v_exp_f32 v59, v59
    v_exp_f32 v60, v60
    v_exp_f32 v61, v61
    v_smfmac_f32_32x32x32_bf16 v[76:91], v[128:131], v[52:59], v0
    v_exp_f32 v62, v62
    v_exp_f32 v63, v63
    v_exp_f32 v64, v64
    v_mfma_f32_32x32x16_bf16 v[44:59], v[108:111], v[4:7], v[12:27]
    v_exp_f32 v65, v65
    v_exp_f32 v66, v66
    v_exp_f32 v67, v67
    v_exp_f32 v68, v68
    v_exp_f32 v69, v69
    v_smfmac_f32_32x32x32_bf16 v[92:107], v[120:123], v[60:67], v0
    v_exp_f32 v70, v70
    v_exp_f32 v71, v71
    v_exp_f32 v72, v72
    v_exp_f32 v73, v73
    v_exp_f32 v74, v74
    v_exp_f32 v75, v75
    v_exp_f32 v44, v44
    v_exp_f32 v45, v45
    v_smfmac_f32_32x32x32_bf16 v[92:107], v[128:131], v[68:75], v0
    v_exp_f32 v46, v46
    v_exp_f32 v47, v47
    v_exp_f32 v48, v48
    v_mfma_f32_32x32x16_bf16 v[60:75], v[108:111], v[8:11], v[28:43]
    ds_read_b128 v[108:111], v132 offset:36864
    s_mov_b64 exec, s[72:73]
    ds_read_b128 v[120:123], v133 offset:34816
    ds_read_b128 v[128:131], v133 offset:35328
    s_mov_b64 exec, -1
    v_exp_f32 v49, v49
    v_exp_f32 v50, v50
    v_exp_f32 v51, v51
    v_exp_f32 v52, v52
    v_exp_f32 v53, v53
    s_waitcnt lgkmcnt(3)
    v_smfmac_f32_32x32x32_bf16 v[76:91], v[116:119], v[44:51], v0
    v_exp_f32 v54, v54
    v_exp_f32 v55, v55
    v_exp_f32 v56, v56
    v_and_b32 v254, 7, v1
    v_lshlrev_b32 v254, 2, v254
    s_lshl_b32 s78, s67, 7
    s_add_u32 s78, s78, 548864
    buffer_load_dword v253, v254, s[44:47], s78 offen sc1
    v_mov_b32 v254, 128
    buffer_load_dword v254, v254, s[48:51], 0 offen sc1
    v_exp_f32 v57, v57
    v_exp_f32 v58, v58
    v_exp_f32 v59, v59
    v_exp_f32 v60, v60
    v_exp_f32 v61, v61
    v_smfmac_f32_32x32x32_bf16 v[76:91], v[124:127], v[52:59], v0
    v_exp_f32 v62, v62
    v_exp_f32 v63, v63
    v_exp_f32 v64, v64
    v_mfma_f32_32x32x16_bf16 v[44:59], v[112:115], v[4:7], v[12:27]
    v_exp_f32 v65, v65
    v_exp_f32 v66, v66
    v_exp_f32 v67, v67
    v_exp_f32 v68, v68
    v_exp_f32 v69, v69
    v_smfmac_f32_32x32x32_bf16 v[92:107], v[116:119], v[60:67], v0
    v_exp_f32 v70, v70
    v_exp_f32 v71, v71
    v_exp_f32 v72, v72
    v_exp_f32 v73, v73
    v_exp_f32 v74, v74
    v_exp_f32 v75, v75
    v_exp_f32 v44, v44
    v_exp_f32 v45, v45
    v_smfmac_f32_32x32x32_bf16 v[92:107], v[124:127], v[68:75], v0
    v_exp_f32 v46, v46
    v_exp_f32 v47, v47
    v_exp_f32 v48, v48
    v_mfma_f32_32x32x16_bf16 v[60:75], v[112:115], v[8:11], v[28:43]
    ds_read_b128 v[112:115], v132 offset:38912
    s_mov_b64 exec, s[72:73]
    ds_read_b128 v[116:119], v133 offset:36864
    ds_read_b128 v[124:127], v133 offset:37376
    s_mov_b64 exec, -1
    v_exp_f32 v49, v49
    v_exp_f32 v50, v50
    v_exp_f32 v51, v51
    v_exp_f32 v52, v52
    v_exp_f32 v53, v53
    s_waitcnt lgkmcnt(3)
    v_smfmac_f32_32x32x32_bf16 v[76:91], v[120:123], v[44:51], v0
    v_exp_f32 v54, v54
    v_exp_f32 v55, v55
    v_exp_f32 v56, v56
    v_exp_f32 v57, v57
    v_exp_f32 v58, v58
    v_exp_f32 v59, v59
    v_exp_f32 v60, v60
    v_exp_f32 v61, v61
    v_smfmac_f32_32x32x32_bf16 v[76:91], v[128:131], v[52:59], v0
    v_exp_f32 v62, v62
    v_exp_f32 v63, v63
    v_exp_f32 v64, v64
    v_mfma_f32_32x32x16_bf16 v[44:59], v[108:111], v[4:7], v[12:27]
    v_exp_f32 v65, v65
    v_exp_f32 v66, v66
    v_exp_f32 v67, v67
    v_exp_f32 v68, v68
    v_exp_f32 v69, v69
    v_smfmac_f32_32x32x32_bf16 v[92:107], v[120:123], v[60:67], v0
    v_exp_f32 v70, v70
    v_exp_f32 v71, v71
    v_exp_f32 v72, v72
    v_exp_f32 v73, v73
    v_exp_f32 v74, v74
    v_exp_f32 v75, v75
    v_exp_f32 v44, v44
    v_exp_f32 v45, v45
    v_smfmac_f32_32x32x32_bf16 v[92:107], v[128:131], v[68:75], v0
    v_exp_f32 v46, v46
    v_exp_f32 v47, v47
    v_exp_f32 v48, v48
    v_mfma_f32_32x32x16_bf16 v[60:75], v[108:111], v[8:11], v[28:43]
    ds_read_b128 v[108:111], v132 offset:40960
    s_mov_b64 exec, s[72:73]
    ds_read_b128 v[120:123], v133 offset:38912
    ds_read_b128 v[128:131], v133 offset:39424
    s_mov_b64 exec, -1
    v_exp_f32 v49, v49
    v_exp_f32 v50, v50
    v_exp_f32 v51, v51
    v_exp_f32 v52, v52
    v_exp_f32 v53, v53
    s_waitcnt lgkmcnt(3)
    v_smfmac_f32_32x32x32_bf16 v[76:91], v[116:119], v[44:51], v0
    v_exp_f32 v54, v54
    v_exp_f32 v55, v55
    v_exp_f32 v56, v56
    v_exp_f32 v57, v57
    v_exp_f32 v58, v58
    v_exp_f32 v59, v59
    v_exp_f32 v60, v60
    v_exp_f32 v61, v61
    v_smfmac_f32_32x32x32_bf16 v[76:91], v[124:127], v[52:59], v0
    v_exp_f32 v62, v62
    v_exp_f32 v63, v63
    v_exp_f32 v64, v64
    v_mfma_f32_32x32x16_bf16 v[44:59], v[112:115], v[4:7], v[12:27]
    v_exp_f32 v65, v65
    v_exp_f32 v66, v66
    v_exp_f32 v67, v67
    v_exp_f32 v68, v68
    v_exp_f32 v69, v69
    v_smfmac_f32_32x32x32_bf16 v[92:107], v[116:119], v[60:67], v0
    v_exp_f32 v70, v70
    v_exp_f32 v71, v71
    v_exp_f32 v72, v72
    v_exp_f32 v73, v73
    v_exp_f32 v74, v74
    v_exp_f32 v75, v75
    v_exp_f32 v44, v44
    v_exp_f32 v45, v45
    v_smfmac_f32_32x32x32_bf16 v[92:107], v[124:127], v[68:75], v0
    v_exp_f32 v46, v46
    v_exp_f32 v47, v47
    v_exp_f32 v48, v48
    v_mfma_f32_32x32x16_bf16 v[60:75], v[112:115], v[8:11], v[28:43]
    ds_read_b128 v[112:115], v132 offset:43008
    s_mov_b64 exec, s[72:73]
    ds_read_b128 v[116:119], v133 offset:40960
    ds_read_b128 v[124:127], v133 offset:41472
    s_mov_b64 exec, -1
    v_exp_f32 v49, v49
    v_exp_f32 v50, v50
    v_exp_f32 v51, v51
    v_exp_f32 v52, v52
    v_exp_f32 v53, v53
    s_waitcnt lgkmcnt(3)
    v_smfmac_f32_32x32x32_bf16 v[76:91], v[120:123], v[44:51], v0
    v_exp_f32 v54, v54
    v_exp_f32 v55, v55
    v_exp_f32 v56, v56
    v_exp_f32 v57, v57
    v_exp_f32 v58, v58
    v_exp_f32 v59, v59
    v_exp_f32 v60, v60
    v_exp_f32 v61, v61
    v_smfmac_f32_32x32x32_bf16 v[76:91], v[128:131], v[52:59], v0
    v_exp_f32 v62, v62
    v_exp_f32 v63, v63
    v_exp_f32 v64, v64
    v_mfma_f32_32x32x16_bf16 v[44:59], v[108:111], v[4:7], v[12:27]
    v_exp_f32 v65, v65
    v_exp_f32 v66, v66
    v_exp_f32 v67, v67
    v_exp_f32 v68, v68
    v_exp_f32 v69, v69
    v_smfmac_f32_32x32x32_bf16 v[92:107], v[120:123], v[60:67], v0
    v_exp_f32 v70, v70
    v_exp_f32 v71, v71
    v_exp_f32 v72, v72
    v_exp_f32 v73, v73
    v_exp_f32 v74, v74
    v_exp_f32 v75, v75
    v_exp_f32 v44, v44
    v_exp_f32 v45, v45
    v_smfmac_f32_32x32x32_bf16 v[92:107], v[128:131], v[68:75], v0
    v_exp_f32 v46, v46
    v_exp_f32 v47, v47
    v_exp_f32 v48, v48
    v_mfma_f32_32x32x16_bf16 v[60:75], v[108:111], v[8:11], v[28:43]
    ds_read_b128 v[108:111], v132 offset:45056
    s_mov_b64 exec, s[72:73]
    ds_read_b128 v[120:123], v133 offset:43008
    ds_read_b128 v[128:131], v133 offset:43520
    s_mov_b64 exec, -1
    v_exp_f32 v49, v49
    v_exp_f32 v50, v50
    v_exp_f32 v51, v51
    v_exp_f32 v52, v52
    v_exp_f32 v53, v53
    s_waitcnt lgkmcnt(3)
    v_smfmac_f32_32x32x32_bf16 v[76:91], v[116:119], v[44:51], v0
    v_exp_f32 v54, v54
    v_exp_f32 v55, v55
    v_exp_f32 v56, v56
    v_exp_f32 v57, v57
    v_exp_f32 v58, v58
    v_exp_f32 v59, v59
    v_exp_f32 v60, v60
    v_exp_f32 v61, v61
    v_smfmac_f32_32x32x32_bf16 v[76:91], v[124:127], v[52:59], v0
    v_exp_f32 v62, v62
    v_exp_f32 v63, v63
    v_exp_f32 v64, v64
    v_mfma_f32_32x32x16_bf16 v[44:59], v[112:115], v[4:7], v[12:27]
    v_exp_f32 v65, v65
    v_exp_f32 v66, v66
    v_exp_f32 v67, v67
    v_exp_f32 v68, v68
    v_exp_f32 v69, v69
    v_smfmac_f32_32x32x32_bf16 v[92:107], v[116:119], v[60:67], v0
    v_exp_f32 v70, v70
    v_exp_f32 v71, v71
    v_exp_f32 v72, v72
    v_exp_f32 v73, v73
    v_exp_f32 v74, v74
    v_exp_f32 v75, v75
    s_setprio 0
    v_exp_f32 v44, v44
    v_exp_f32 v45, v45
    v_smfmac_f32_32x32x32_bf16 v[92:107], v[124:127], v[68:75], v0
    v_exp_f32 v46, v46
    v_exp_f32 v47, v47
    v_exp_f32 v48, v48
    v_mfma_f32_32x32x16_bf16 v[60:75], v[112:115], v[8:11], v[28:43]
    ds_read_b128 v[112:115], v132 offset:47104
    s_mov_b64 exec, s[72:73]
    ds_read_b128 v[116:119], v133 offset:45056
    ds_read_b128 v[124:127], v133 offset:45568
    s_mov_b64 exec, -1
    v_exp_f32 v49, v49
    v_exp_f32 v50, v50
    v_exp_f32 v51, v51
    v_exp_f32 v52, v52
    v_exp_f32 v53, v53
    s_waitcnt lgkmcnt(3)
    v_smfmac_f32_32x32x32_bf16 v[76:91], v[120:123], v[44:51], v0
    v_exp_f32 v54, v54
    v_exp_f32 v55, v55
    v_exp_f32 v56, v56
    v_exp_f32 v57, v57
    v_exp_f32 v58, v58
    v_exp_f32 v59, v59
    v_exp_f32 v60, v60
    v_exp_f32 v61, v61
    v_smfmac_f32_32x32x32_bf16 v[76:91], v[128:131], v[52:59], v0
    v_exp_f32 v62, v62
    v_exp_f32 v63, v63
    v_exp_f32 v64, v64
    v_mfma_f32_32x32x16_bf16 v[44:59], v[108:111], v[4:7], v[12:27]
    v_exp_f32 v65, v65
    v_exp_f32 v66, v66
    v_exp_f32 v67, v67
    v_exp_f32 v68, v68
    v_exp_f32 v69, v69
    v_smfmac_f32_32x32x32_bf16 v[92:107], v[120:123], v[60:67], v0
    v_exp_f32 v70, v70
    v_exp_f32 v71, v71
    v_exp_f32 v72, v72
    v_exp_f32 v73, v73
    v_exp_f32 v74, v74
    v_exp_f32 v75, v75
    v_exp_f32 v44, v44
    v_exp_f32 v45, v45
    v_smfmac_f32_32x32x32_bf16 v[92:107], v[128:131], v[68:75], v0
    v_exp_f32 v46, v46
    v_exp_f32 v47, v47
    v_exp_f32 v48, v48
    v_mfma_f32_32x32x16_bf16 v[60:75], v[108:111], v[8:11], v[28:43]
    ds_read_b128 v[108:111], v132 offset:49152
    s_mov_b64 exec, s[72:73]
    ds_read_b128 v[120:123], v133 offset:47104
    ds_read_b128 v[128:131], v133 offset:47616
    s_mov_b64 exec, -1
    v_exp_f32 v49, v49
    v_exp_f32 v50, v50
    v_exp_f32 v51, v51
    v_exp_f32 v52, v52
    v_exp_f32 v53, v53
    s_waitcnt lgkmcnt(3)
    v_smfmac_f32_32x32x32_bf16 v[76:91], v[116:119], v[44:51], v0
    v_exp_f32 v54, v54
    v_exp_f32 v55, v55
    v_exp_f32 v56, v56
    v_exp_f32 v57, v57
    v_exp_f32 v58, v58
    v_exp_f32 v59, v59
    v_exp_f32 v60, v60
    v_exp_f32 v61, v61
    v_smfmac_f32_32x32x32_bf16 v[76:91], v[124:127], v[52:59], v0
    v_exp_f32 v62, v62
    v_exp_f32 v63, v63
    v_exp_f32 v64, v64
    v_mfma_f32_32x32x16_bf16 v[44:59], v[112:115], v[4:7], v[12:27]
    v_exp_f32 v65, v65
    v_exp_f32 v66, v66
    v_exp_f32 v67, v67
    v_exp_f32 v68, v68
    v_exp_f32 v69, v69
    v_smfmac_f32_32x32x32_bf16 v[92:107], v[116:119], v[60:67], v0
    v_exp_f32 v70, v70
    v_exp_f32 v71, v71
    v_exp_f32 v72, v72
    v_exp_f32 v73, v73
    v_exp_f32 v74, v74
    v_exp_f32 v75, v75
    v_exp_f32 v44, v44
    v_exp_f32 v45, v45
    v_smfmac_f32_32x32x32_bf16 v[92:107], v[124:127], v[68:75], v0
    v_exp_f32 v46, v46
    v_exp_f32 v47, v47
    v_exp_f32 v48, v48
    v_mfma_f32_32x32x16_bf16 v[60:75], v[112:115], v[8:11], v[28:43]
    ds_read_b128 v[112:115], v132 offset:51200
    s_mov_b64 exec, s[72:73]
    ds_read_b128 v[116:119], v133 offset:49152
    ds_read_b128 v[124:127], v133 offset:49664
    s_mov_b64 exec, -1
    v_exp_f32 v49, v49
    v_exp_f32 v50, v50
    v_exp_f32 v51, v51
    v_exp_f32 v52, v52
    v_exp_f32 v53, v53
    s_waitcnt lgkmcnt(3)
    v_smfmac_f32_32x32x32_bf16 v[76:91], v[120:123], v[44:51], v0
    v_exp_f32 v54, v54
    v_exp_f32 v55, v55
    v_exp_f32 v56, v56
    v_exp_f32 v57, v57
    v_exp_f32 v58, v58
    v_exp_f32 v59, v59
    v_exp_f32 v60, v60
    v_exp_f32 v61, v61
    v_smfmac_f32_32x32x32_bf16 v[76:91], v[128:131], v[52:59], v0
    v_exp_f32 v62, v62
    v_exp_f32 v63, v63
    v_exp_f32 v64, v64
    v_mfma_f32_32x32x16_bf16 v[44:59], v[108:111], v[4:7], v[12:27]
    v_exp_f32 v65, v65
    v_exp_f32 v66, v66
    v_exp_f32 v67, v67
    v_exp_f32 v68, v68
    v_exp_f32 v69, v69
    v_smfmac_f32_32x32x32_bf16 v[92:107], v[120:123], v[60:67], v0
    v_exp_f32 v70, v70
    v_exp_f32 v71, v71
    v_exp_f32 v72, v72
    v_exp_f32 v73, v73
    v_exp_f32 v74, v74
    v_exp_f32 v75, v75
    v_exp_f32 v44, v44
    v_exp_f32 v45, v45
    v_smfmac_f32_32x32x32_bf16 v[92:107], v[128:131], v[68:75], v0
    v_exp_f32 v46, v46
    v_exp_f32 v47, v47
    v_exp_f32 v48, v48
    v_mfma_f32_32x32x16_bf16 v[60:75], v[108:111], v[8:11], v[28:43]
    ds_read_b128 v[108:111], v132 offset:53248
    s_mov_b64 exec, s[72:73]
    ds_read_b128 v[120:123], v133 offset:51200
    ds_read_b128 v[128:131], v133 offset:51712
    s_mov_b64 exec, -1
    v_exp_f32 v49, v49
    v_exp_f32 v50, v50
    v_exp_f32 v51, v51
    v_exp_f32 v52, v52
    v_exp_f32 v53, v53
    s_waitcnt lgkmcnt(3)
    v_smfmac_f32_32x32x32_bf16 v[76:91], v[116:119], v[44:51], v0
    v_exp_f32 v54, v54
    v_exp_f32 v55, v55
    v_exp_f32 v56, v56
    v_exp_f32 v57, v57
    v_exp_f32 v58, v58
    v_exp_f32 v59, v59
    v_exp_f32 v60, v60
    v_exp_f32 v61, v61
    v_smfmac_f32_32x32x32_bf16 v[76:91], v[124:127], v[52:59], v0
    v_exp_f32 v62, v62
    v_exp_f32 v63, v63
    v_exp_f32 v64, v64
    v_mfma_f32_32x32x16_bf16 v[44:59], v[112:115], v[4:7], v[12:27]
    v_exp_f32 v65, v65
    v_exp_f32 v66, v66
    v_exp_f32 v67, v67
    v_exp_f32 v68, v68
    v_exp_f32 v69, v69
    v_smfmac_f32_32x32x32_bf16 v[92:107], v[116:119], v[60:67], v0
    v_exp_f32 v70, v70
    v_exp_f32 v71, v71
    v_exp_f32 v72, v72
    v_exp_f32 v73, v73
    v_exp_f32 v74, v74
    v_exp_f32 v75, v75
    v_exp_f32 v44, v44
    v_exp_f32 v45, v45
    v_smfmac_f32_32x32x32_bf16 v[92:107], v[124:127], v[68:75], v0
    v_exp_f32 v46, v46
    v_exp_f32 v47, v47
    v_exp_f32 v48, v48
    v_mfma_f32_32x32x16_bf16 v[60:75], v[112:115], v[8:11], v[28:43]
    ds_read_b128 v[112:115], v132 offset:55296
    s_mov_b64 exec, s[72:73]
    ds_read_b128 v[116:119], v133 offset:53248
    ds_read_b128 v[124:127], v133 offset:53760
    s_mov_b64 exec, -1
    v_exp_f32 v49, v49
    v_exp_f32 v50, v50
    v_exp_f32 v51, v51
    v_exp_f32 v52, v52
    v_exp_f32 v53, v53
    s_waitcnt lgkmcnt(3)
    v_smfmac_f32_32x32x32_bf16 v[76:91], v[120:123], v[44:51], v0
    v_exp_f32 v54, v54
    v_exp_f32 v55, v55
    v_exp_f32 v56, v56
    v_exp_f32 v57, v57
    v_exp_f32 v58, v58
    v_exp_f32 v59, v59
    v_exp_f32 v60, v60
    v_exp_f32 v61, v61
    v_smfmac_f32_32x32x32_bf16 v[76:91], v[128:131], v[52:59], v0
    v_exp_f32 v62, v62
    v_exp_f32 v63, v63
    v_exp_f32 v64, v64
    v_mfma_f32_32x32x16_bf16 v[44:59], v[108:111], v[4:7], v[12:27]
    v_exp_f32 v65, v65
    v_exp_f32 v66, v66
    v_exp_f32 v67, v67
    v_exp_f32 v68, v68
    v_exp_f32 v69, v69
    v_smfmac_f32_32x32x32_bf16 v[92:107], v[120:123], v[60:67], v0
    v_exp_f32 v70, v70
    v_exp_f32 v71, v71
    v_exp_f32 v72, v72
    v_exp_f32 v73, v73
    v_exp_f32 v74, v74
    v_exp_f32 v75, v75
    v_exp_f32 v44, v44
    v_exp_f32 v45, v45
    v_smfmac_f32_32x32x32_bf16 v[92:107], v[128:131], v[68:75], v0
    v_exp_f32 v46, v46
    v_exp_f32 v47, v47
    v_exp_f32 v48, v48
    v_mfma_f32_32x32x16_bf16 v[60:75], v[108:111], v[8:11], v[28:43]
    ds_read_b128 v[108:111], v132 offset:57344
    s_mov_b64 exec, s[72:73]
    ds_read_b128 v[120:123], v133 offset:55296
    ds_read_b128 v[128:131], v133 offset:55808
    s_mov_b64 exec, -1
    v_exp_f32 v49, v49
    v_exp_f32 v50, v50
    v_exp_f32 v51, v51
    v_exp_f32 v52, v52
    v_exp_f32 v53, v53
    s_waitcnt lgkmcnt(3)
    v_smfmac_f32_32x32x32_bf16 v[76:91], v[116:119], v[44:51], v0
    v_exp_f32 v54, v54
    v_exp_f32 v55, v55
    v_exp_f32 v56, v56
    v_exp_f32 v57, v57
    v_exp_f32 v58, v58
    v_exp_f32 v59, v59
    v_exp_f32 v60, v60
    v_exp_f32 v61, v61
    v_smfmac_f32_32x32x32_bf16 v[76:91], v[124:127], v[52:59], v0
    v_exp_f32 v62, v62
    v_exp_f32 v63, v63
    v_exp_f32 v64, v64
    v_mfma_f32_32x32x16_bf16 v[44:59], v[112:115], v[4:7], v[12:27]
    v_exp_f32 v65, v65
    v_exp_f32 v66, v66
    v_exp_f32 v67, v67
    v_exp_f32 v68, v68
    v_exp_f32 v69, v69
    v_smfmac_f32_32x32x32_bf16 v[92:107], v[116:119], v[60:67], v0
    v_exp_f32 v70, v70
    v_exp_f32 v71, v71
    v_exp_f32 v72, v72
    v_exp_f32 v73, v73
    v_exp_f32 v74, v74
    v_exp_f32 v75, v75
    v_exp_f32 v44, v44
    v_exp_f32 v45, v45
    v_smfmac_f32_32x32x32_bf16 v[92:107], v[124:127], v[68:75], v0
    v_exp_f32 v46, v46
    v_exp_f32 v47, v47
    v_exp_f32 v48, v48
    v_mfma_f32_32x32x16_bf16 v[60:75], v[112:115], v[8:11], v[28:43]
    ds_read_b128 v[112:115], v132 offset:59392
    s_mov_b64 exec, s[72:73]
    ds_read_b128 v[116:119], v133 offset:57344
    ds_read_b128 v[124:127], v133 offset:57856
    s_mov_b64 exec, -1
    v_exp_f32 v49, v49
    v_exp_f32 v50, v50
    v_exp_f32 v51, v51
    v_exp_f32 v52, v52
    v_exp_f32 v53, v53
    s_waitcnt lgkmcnt(3)
    v_smfmac_f32_32x32x32_bf16 v[76:91], v[120:123], v[44:51], v0
    v_exp_f32 v54, v54
    v_exp_f32 v55, v55
    v_exp_f32 v56, v56
    v_exp_f32 v57, v57
    v_exp_f32 v58, v58
    v_exp_f32 v59, v59
    v_exp_f32 v60, v60
    v_exp_f32 v61, v61
    v_smfmac_f32_32x32x32_bf16 v[76:91], v[128:131], v[52:59], v0
    v_exp_f32 v62, v62
    v_exp_f32 v63, v63
    v_exp_f32 v64, v64
    v_mfma_f32_32x32x16_bf16 v[44:59], v[108:111], v[4:7], v[12:27]
    v_exp_f32 v65, v65
    v_exp_f32 v66, v66
    v_exp_f32 v67, v67
    v_exp_f32 v68, v68
    v_exp_f32 v69, v69
    v_smfmac_f32_32x32x32_bf16 v[92:107], v[120:123], v[60:67], v0
    v_exp_f32 v70, v70
    v_exp_f32 v71, v71
    v_exp_f32 v72, v72
    v_exp_f32 v73, v73
    v_exp_f32 v74, v74
    v_exp_f32 v75, v75
    v_exp_f32 v44, v44
    v_exp_f32 v45, v45
    v_smfmac_f32_32x32x32_bf16 v[92:107], v[128:131], v[68:75], v0
    v_exp_f32 v46, v46
    v_exp_f32 v47, v47
    v_exp_f32 v48, v48
    v_mfma_f32_32x32x16_bf16 v[60:75], v[108:111], v[8:11], v[28:43]
    ds_read_b128 v[108:111], v132 offset:61440
    s_mov_b64 exec, s[72:73]
    ds_read_b128 v[120:123], v133 offset:59392
    ds_read_b128 v[128:131], v133 offset:59904
    s_mov_b64 exec, -1
    v_exp_f32 v49, v49
    v_exp_f32 v50, v50
    v_exp_f32 v51, v51
    v_exp_f32 v52, v52
    v_exp_f32 v53, v53
    s_waitcnt lgkmcnt(3)
    v_smfmac_f32_32x32x32_bf16 v[76:91], v[116:119], v[44:51], v0
    v_exp_f32 v54, v54
    v_exp_f32 v55, v55
    v_exp_f32 v56, v56
    s_lshl_b32 s78, s67, 1
    s_add_u32 s78, s78, s69
    s_lshl_b32 s78, s78, 6
    s_lshl_b32 s79, s68, 3
    s_add_u32 s78, s78, s79
    s_lshl_b32 s79, s70, 1
    s_add_u32 s78, s78, s79
    s_lshl_b32 s78, s78, 10
    s_add_u32 s87, s78, 1048576
    v_exp_f32 v57, v57
    v_exp_f32 v58, v58
    v_exp_f32 v59, v59
    v_exp_f32 v60, v60
    v_exp_f32 v61, v61
    v_smfmac_f32_32x32x32_bf16 v[76:91], v[124:127], v[52:59], v0
    v_exp_f32 v62, v62
    v_exp_f32 v63, v63
    v_exp_f32 v64, v64
    v_mfma_f32_32x32x16_bf16 v[44:59], v[112:115], v[4:7], v[12:27]
    v_exp_f32 v65, v65
    v_exp_f32 v66, v66
    v_exp_f32 v67, v67
    v_exp_f32 v68, v68
    v_exp_f32 v69, v69
    v_smfmac_f32_32x32x32_bf16 v[92:107], v[116:119], v[60:67], v0
    v_exp_f32 v70, v70
    v_exp_f32 v71, v71
    v_exp_f32 v72, v72
    v_exp_f32 v73, v73
    v_exp_f32 v74, v74
    v_exp_f32 v75, v75
    v_exp_f32 v44, v44
    v_exp_f32 v45, v45
    v_smfmac_f32_32x32x32_bf16 v[92:107], v[124:127], v[68:75], v0
    v_exp_f32 v46, v46
    v_exp_f32 v47, v47
    v_exp_f32 v48, v48
    v_mfma_f32_32x32x16_bf16 v[60:75], v[112:115], v[8:11], v[28:43]
    ds_read_b128 v[112:115], v132 offset:63488
    s_mov_b64 exec, s[72:73]
    ds_read_b128 v[116:119], v133 offset:61440
    ds_read_b128 v[124:127], v133 offset:61952
    s_mov_b64 exec, -1
    v_exp_f32 v49, v49
    v_exp_f32 v50, v50
    v_exp_f32 v51, v51
    v_exp_f32 v52, v52
    v_exp_f32 v53, v53
    s_waitcnt lgkmcnt(3)
    v_smfmac_f32_32x32x32_bf16 v[76:91], v[120:123], v[44:51], v0
    v_exp_f32 v54, v54
    v_exp_f32 v55, v55
    v_exp_f32 v56, v56
    v_exp_f32 v57, v57
    v_exp_f32 v58, v58
    v_exp_f32 v59, v59
    v_exp_f32 v60, v60
    v_exp_f32 v61, v61
    v_smfmac_f32_32x32x32_bf16 v[76:91], v[128:131], v[52:59], v0
    v_exp_f32 v62, v62
    v_exp_f32 v63, v63
    v_exp_f32 v64, v64
    v_mfma_f32_32x32x16_bf16 v[44:59], v[108:111], v[4:7], v[12:27]
    v_exp_f32 v65, v65
    v_exp_f32 v66, v66
    v_exp_f32 v67, v67
    v_exp_f32 v68, v68
    v_exp_f32 v69, v69
    v_smfmac_f32_32x32x32_bf16 v[92:107], v[120:123], v[60:67], v0
    v_exp_f32 v70, v70
    v_exp_f32 v71, v71
    v_exp_f32 v72, v72
    v_exp_f32 v73, v73
    v_exp_f32 v74, v74
    v_exp_f32 v75, v75
    v_exp_f32 v44, v44
    v_exp_f32 v45, v45
    v_smfmac_f32_32x32x32_bf16 v[92:107], v[128:131], v[68:75], v0
    v_exp_f32 v46, v46
    v_exp_f32 v47, v47
    v_exp_f32 v48, v48
    v_mfma_f32_32x32x16_bf16 v[60:75], v[108:111], v[8:11], v[28:43]
    s_mov_b64 exec, s[72:73]
    ds_read_b128 v[120:123], v133 offset:63488
    ds_read_b128 v[128:131], v133 offset:64000
    s_mov_b64 exec, -1
    v_exp_f32 v49, v49
    v_exp_f32 v50, v50
    v_exp_f32 v51, v51
    v_exp_f32 v52, v52
    v_exp_f32 v53, v53
    s_waitcnt lgkmcnt(2)
    v_smfmac_f32_32x32x32_bf16 v[76:91], v[116:119], v[44:51], v0
    v_exp_f32 v54, v54
    v_exp_f32 v55, v55
    v_exp_f32 v56, v56
    v_exp_f32 v57, v57
    v_exp_f32 v58, v58
    v_exp_f32 v59, v59
    v_exp_f32 v60, v60
    v_exp_f32 v61, v61
    v_smfmac_f32_32x32x32_bf16 v[76:91], v[124:127], v[52:59], v0
    v_exp_f32 v62, v62
    v_exp_f32 v63, v63
    v_exp_f32 v64, v64
    v_mfma_f32_32x32x16_bf16 v[44:59], v[112:115], v[4:7], v[12:27]
    v_exp_f32 v65, v65
    v_exp_f32 v66, v66
    v_exp_f32 v67, v67
    v_exp_f32 v68, v68
    v_exp_f32 v69, v69
    v_smfmac_f32_32x32x32_bf16 v[92:107], v[116:119], v[60:67], v0
    v_exp_f32 v70, v70
    v_exp_f32 v71, v71
    v_exp_f32 v72, v72
    v_exp_f32 v73, v73
    v_exp_f32 v74, v74
    v_exp_f32 v75, v75
    v_exp_f32 v44, v44
    v_exp_f32 v45, v45
    v_smfmac_f32_32x32x32_bf16 v[92:107], v[124:127], v[68:75], v0
    v_exp_f32 v46, v46
    v_exp_f32 v47, v47
    v_exp_f32 v48, v48
    v_mfma_f32_32x32x16_bf16 v[60:75], v[112:115], v[8:11], v[28:43]
    v_exp_f32 v49, v49
    v_exp_f32 v50, v50
    v_exp_f32 v51, v51
    v_exp_f32 v52, v52
    v_exp_f32 v53, v53
    s_waitcnt lgkmcnt(0)
    v_smfmac_f32_32x32x32_bf16 v[76:91], v[120:123], v[44:51], v0
    v_exp_f32 v54, v54
    v_exp_f32 v55, v55
    v_exp_f32 v56, v56
    v_exp_f32 v57, v57
    v_exp_f32 v58, v58
    v_exp_f32 v59, v59
    v_exp_f32 v60, v60
    v_exp_f32 v61, v61
    v_smfmac_f32_32x32x32_bf16 v[76:91], v[128:131], v[52:59], v0
    v_exp_f32 v62, v62
    v_exp_f32 v63, v63
    v_exp_f32 v64, v64
    s_nop 0
    v_exp_f32 v65, v65
    v_exp_f32 v66, v66
    v_exp_f32 v67, v67
    v_exp_f32 v68, v68
    v_exp_f32 v69, v69
    v_smfmac_f32_32x32x32_bf16 v[92:107], v[120:123], v[60:67], v0
    v_exp_f32 v70, v70
    v_exp_f32 v71, v71
    v_exp_f32 v72, v72
    v_exp_f32 v73, v73
    v_exp_f32 v74, v74
    v_exp_f32 v75, v75
    s_nop 1
    v_smfmac_f32_32x32x32_bf16 v[92:107], v[128:131], v[68:75], v0
    s_lshl_b32 s78, s64, 12
    s_add_u32 m0, s78, 2048
    s_mov_b32 s79, 475136
    buffer_load_dwordx4 v134, s[52:55], s79 offen lds
    s_lshl_b32 s78, s64, 12
    s_add_u32 m0, s78, 0
    s_mov_b32 s79, 491520
    buffer_load_dwordx4 v134, s[52:55], s79 offen lds
    s_lshl_b32 s78, s64, 12
    s_add_u32 m0, s78, 1024
    s_mov_b32 s79, 507904
    buffer_load_dwordx4 v134, s[52:55], s79 offen lds
L_tail:
    s_waitcnt vmcnt(3)
    s_nop 0
    v_or_b32 v254, s97, v254
    v_cmp_eq_u32 vcc, v253, v254
    s_cmp_eq_u64 vcc, exec
    s_cselect_b32 s98, 1, 0
    v_sub_f32 v46, 1.0, v252
    v_cvt_pk_bf16_f32 v46, v46, v46
    v_lshlrev_b32 v46, 16, v46
    s_cmp_eq_u32 s65, 0
    s_cselect_b64 s[88:89], -1, 0
    v_cndmask_b32 v46, v46, v252, s[88:89]
    v_pk_mul_f32 v[48:49], v[76:77], 0
    v_pk_fma_f32 v[48:49], v[78:79], 0, v[48:49]
    v_pk_fma_f32 v[48:49], v[80:81], 0, v[48:49]
    v_pk_fma_f32 v[48:49], v[82:83], 0, v[48:49]
    v_pk_fma_f32 v[48:49], v[92:93], 0, v[48:49]
    v_pk_fma_f32 v[48:49], v[94:95], 0, v[48:49]
    v_pk_fma_f32 v[48:49], v[96:97], 0, v[48:49]
    v_pk_fma_f32 v[48:49], v[98:99], 0, v[48:49]
    v_max_f32 v45, v84, v100
    v_add_f32 v44, v48, v49
    v_add_f32 v44, v44, v45
    s_mov_b32 s78, 0x5d800000
    v_cmp_gt_f32 vcc, s78, v44
    s_cmp_eq_u32 s74, 2
    s_cbranch_scc1 L_fin
    s_cmp_eq_u64 vcc, exec
    s_cbranch_scc1 L_fin
    s_mov_b32 s74, 2
    s_mov_b32 s96, 0
    v_mov_b32 v112, 0xff800000
    v_mov_b32 v114, 0xff800000
    v_mov_b32 v113, v2
    s_mov_b32 s78, 0
L_maxloop:
    ds_read_b128 v[108:111], v113
    s_waitcnt lgkmcnt(0)
    v_mfma_f32_32x32x16_bf16 v[44:59], v[108:111], v[4:7], 0
    v_mfma_f32_32x32x16_bf16 v[60:75], v[108:111], v[8:11], 0
    s_nop 15
    v_max3_f32 v112, v112, v44, v45
    v_max3_f32 v114, v114, v60, v61
    v_max3_f32 v112, v112, v46, v47
    v_max3_f32 v114, v114, v62, v63
    v_max3_f32 v112, v112, v48, v49
    v_max3_f32 v114, v114, v64, v65
    v_max3_f32 v112, v112, v50, v51
    v_max3_f32 v114, v114, v66, v67
    v_max3_f32 v112, v112, v52, v53
    v_max3_f32 v114, v114, v68, v69
    v_max3_f32 v112, v112, v54, v55
    v_max3_f32 v114, v114, v70, v71
    v_max3_f32 v112, v112, v56, v57
    v_max3_f32 v114, v114, v72, v73
    v_max3_f32 v112, v112, v58, v59
    v_max3_f32 v114, v114, v74, v75
    v_add_u32 v113, 2048, v113
    s_add_u32 s78, s78, 1
    s_cmp_lt_u32 s78, 64
    s_cbranch_scc1 L_maxloop
    v_mov_b32 v113, v112
    s_nop 1
    v_permlane32_swap_b32 v112, v113
    s_nop 1
    v_max_f32 v112, v112, v113
    v_mov_b32 v115, v114
    s_nop 1
    v_permlane32_swap_b32 v114, v115
    s_nop 1
    v_max_f32 v114, v114, v115
    v_pk_mul_f32 v[12:13], v[112:113], -1.0 op_sel_hi:[0,0]
    v_pk_mul_f32 v[14:15], v[112:113], -1.0 op_sel_hi:[0,0]
    v_pk_mul_f32 v[16:17], v[112:113], -1.0 op_sel_hi:[0,0]
    v_pk_mul_f32 v[18:19], v[112:113], -1.0 op_sel_hi:[0,0]
    v_pk_mul_f32 v[20:21], v[112:113], -1.0 op_sel_hi:[0,0]
    v_pk_mul_f32 v[22:23], v[112:113], -1.0 op_sel_hi:[0,0]
    v_pk_mul_f32 v[24:25], v[112:113], -1.0 op_sel_hi:[0,0]
    v_pk_mul_f32 v[26:27], v[112:113], -1.0 op_sel_hi:[0,0]
    v_pk_mul_f32 v[28:29], v[114:115], -1.0 op_sel_hi:[0,0]
    v_pk_mul_f32 v[30:31], v[114:115], -1.0 op_sel_hi:[0,0]
    v_pk_mul_f32 v[32:33], v[114:115], -1.0 op_sel_hi:[0,0]
    v_pk_mul_f32 v[34:35], v[114:115], -1.0 op_sel_hi:[0,0]
    v_pk_mul_f32 v[36:37], v[114:115], -1.0 op_sel_hi:[0,0]
    v_pk_mul_f32 v[38:39], v[114:115], -1.0 op_sel_hi:[0,0]
    v_pk_mul_f32 v[40:41], v[114:115], -1.0 op_sel_hi:[0,0]
    v_pk_mul_f32 v[42:43], v[114:115], -1.0 op_sel_hi:[0,0]
    s_waitcnt vmcnt(0)
    s_branch L_restart
L_fin:
    v_rcp_f32 v44, v84
    v_rcp_f32 v45, v100
    s_nop 0
    v_mul_f32 v44, v44, v46
    v_mul_f32 v45, v45, v46
    v_pk_mul_f32 v[76:77], v[76:77], v[44:45] op_sel_hi:[1,0]
    v_pk_mul_f32 v[92:93], v[92:93], v[44:45] op_sel:[0,1] op_sel_hi:[1,1]
    v_pk_mul_f32 v[78:79], v[78:79], v[44:45] op_sel_hi:[1,0]
    v_pk_mul_f32 v[94:95], v[94:95], v[44:45] op_sel:[0,1] op_sel_hi:[1,1]
    v_pk_mul_f32 v[80:81], v[80:81], v[44:45] op_sel_hi:[1,0]
    v_pk_mul_f32 v[96:97], v[96:97], v[44:45] op_sel:[0,1] op_sel_hi:[1,1]
    v_pk_mul_f32 v[82:83], v[82:83], v[44:45] op_sel_hi:[1,0]
    v_pk_mul_f32 v[98:99], v[98:99], v[44:45] op_sel:[0,1] op_sel_hi:[1,1]
    v_cvt_pk_bf16_f32 v48, v76, v77
    v_cvt_pk_bf16_f32 v52, v92, v93
    v_cvt_pk_bf16_f32 v49, v78, v79
    v_cvt_pk_bf16_f32 v53, v94, v95
    v_cvt_pk_bf16_f32 v50, v80, v81
    v_cvt_pk_bf16_f32 v54, v96, v97
    v_cvt_pk_bf16_f32 v51, v82, v83
    v_cvt_pk_bf16_f32 v55, v98, v99
    v_lshlrev_b32 v60, 4, v1
    buffer_store_dwordx4 v[48:51], v60, s[44:47], s87 offen sc1
    buffer_store_dwordx4 v[52:55], v60, s[44:47], s87 offen offset:1024 sc1
    s_waitcnt vmcnt(2)
    ds_read_b64_tr_b16 v[108:109], v135 offset:2048
    ds_read_b64_tr_b16 v[110:111], v135 offset:2560
    ds_read_b64_tr_b16 v[112:113], v135 offset:0
    ds_read_b64_tr_b16 v[114:115], v135 offset:512
    ds_read_b64_tr_b16 v[116:117], v135 offset:1024
    ds_read_b64_tr_b16 v[118:119], v135 offset:1536
    s_and_b32 s80, s68, 1
    s_lshl_b32 s81, s67, 1
    s_add_u32 s81, s81, s80
    s_lshl_b32 s82, s69, 5
    s_lshl_b32 s83, s70, 1
    s_add_u32 s82, s82, s83
    s_lshl_b32 s84, s82, 10
    s_lshl_b32 s85, s81, 16
    s_add_u32 s85, s85, s84
    s_add_u32 s85, s85, 1048576
    s_add_u32 s84, s84, 32768
    s_lshl_b32 s82, s69, 15
    s_add_u32 s82, s82, 32768
    v_add_u32 v66, s82, v60
    v_and_b32 v67, 31, v1
    s_lshl_b32 s81, s81, 5
    v_add_u32 v67, s81, v67
    v_lshlrev_b32 v67, 10, v67
    v_lshrrev_b32 v63, 5, v1
    v_lshl_add_u32 v67, v63, 4, v67
    s_lshr_b32 s80, s68, 1
    s_lshl_b32 s80, s80, 8
    s_lshl_b32 s81, s70, 6
    s_add_u32 s80, s80, s81
    s_lshl_b32 s81, s69, 5
    s_add_u32 s80, s80, s81
    v_add_u32 v67, s80, v67
    s_lshl_b32 s78, s64, 11
    v_add_u32 v63, s78, v60
    s_xor_b32 s79, s64, 4
    s_lshl_b32 s79, s79, 11
    v_add_u32 v64, s79, v60
    s_waitcnt vmcnt(0)
    s_barrier
    s_cmp_eq_u32 s92, 1
    s_cbranch_scc0 L_nosig2
    s_lshl_b32 s78, s67, 7
    s_add_u32 s78, s78, 524288
    s_lshl_b32 s79, s68, 2
    v_mov_b32 v61, s79
    v_mov_b32 v62, s77
    v_cmp_eq_u32 vcc, 0, v1
    s_and_saveexec_b64 s[82:83], vcc
    s_cmp_eq_u32 s98, 1
    s_cbranch_scc1 L_fst_fast
    buffer_store_dword v62, v61, s[44:47], s78 offen sc1
    s_branch L_fst_j
L_fst_fast:
    buffer_store_dword v62, v61, s[44:47], s78 offen
L_fst_j:
    s_mov_b64 exec, s[82:83]
    v_and_b32 v61, 7, v1
    v_lshlrev_b32 v61, 2, v61
    s_mov_b32 s79, 0
L_poll2:
    buffer_load_dword v62, v61, s[44:47], s78 offen sc1
    s_waitcnt vmcnt(0)
    v_cmp_eq_u32 vcc, s77, v62
    s_cmp_eq_u64 vcc, exec
    s_cbranch_scc1 L_poll2_done
    s_add_u32 s79, s79, 1
    s_cmp_lt_u32 s79, 8192
    s_cbranch_scc0 L_poll2_done
    s_branch L_poll2
L_poll2_done:
L_nosig2:
    s_barrier
    s_add_u32 m0, s84, 0
    s_add_u32 s78, s85, 0
    buffer_load_dwordx4 v60, s[44:47], s78 offen sc1 lds
    s_add_u32 m0, s84, 1024
    s_add_u32 s78, s85, 1024
    buffer_load_dwordx4 v60, s[44:47], s78 offen sc1 lds
    s_add_u32 m0, s84, 8192
    s_add_u32 s78, s85, 8192
    buffer_load_dwordx4 v60, s[44:47], s78 offen sc1 lds
    s_add_u32 m0, s84, 9216
    s_add_u32 s78, s85, 9216
    buffer_load_dwordx4 v60, s[44:47], s78 offen sc1 lds
    s_waitcnt vmcnt(2)
    s_barrier
    ds_read_b128 v[12:15], v66 offset:0
    ds_read_b128 v[16:19], v66 offset:1024
    ds_read_b128 v[20:23], v66 offset:2048
    ds_read_b128 v[24:27], v66 offset:3072
    ds_read_b128 v[28:31], v66 offset:4096
    ds_read_b128 v[32:35], v66 offset:5120
    ds_read_b128 v[36:39], v66 offset:6144
    ds_read_b128 v[40:43], v66 offset:7168
    s_add_u32 m0, s84, 16384
    s_add_u32 s78, s85, 16384
    buffer_load_dwordx4 v60, s[44:47], s78 offen sc1 lds
    s_add_u32 m0, s84, 17408
    s_add_u32 s78, s85, 17408
    buffer_load_dwordx4 v60, s[44:47], s78 offen sc1 lds
    s_add_u32 m0, s84, 24576
    s_add_u32 s78, s85, 24576
    buffer_load_dwordx4 v60, s[44:47], s78 offen sc1 lds
    s_add_u32 m0, s84, 25600
    s_add_u32 s78, s85, 25600
    buffer_load_dwordx4 v60, s[44:47], s78 offen sc1 lds
    s_waitcnt lgkmcnt(7)
    v_mfma_f32_32x32x16_bf16 v[76:91], v[136:139], v[12:15], 0
    s_waitcnt lgkmcnt(6)
    v_mfma_f32_32x32x16_bf16 v[76:91], v[140:143], v[16:19], v[76:91]
    s_waitcnt lgkmcnt(5)
    v_mfma_f32_32x32x16_bf16 v[76:91], v[144:147], v[20:23], v[76:91]
    s_waitcnt lgkmcnt(4)
    v_mfma_f32_32x32x16_bf16 v[76:91], v[148:151], v[24:27], v[76:91]
    s_waitcnt lgkmcnt(3)
    v_mfma_f32_32x32x16_bf16 v[76:91], v[152:155], v[28:31], v[76:91]
    s_waitcnt lgkmcnt(2)
    v_mfma_f32_32x32x16_bf16 v[76:91], v[156:159], v[32:35], v[76:91]
    s_waitcnt lgkmcnt(1)
    v_mfma_f32_32x32x16_bf16 v[76:91], v[160:163], v[36:39], v[76:91]
    s_waitcnt lgkmcnt(0)
    v_mfma_f32_32x32x16_bf16 v[76:91], v[164:167], v[40:43], v[76:91]
    s_waitcnt vmcnt(4)
    s_barrier
    ds_read_b128 v[12:15], v66 offset:8192
    ds_read_b128 v[16:19], v66 offset:9216
    ds_read_b128 v[20:23], v66 offset:10240
    ds_read_b128 v[24:27], v66 offset:11264
    ds_read_b128 v[28:31], v66 offset:12288
    ds_read_b128 v[32:35], v66 offset:13312
    ds_read_b128 v[36:39], v66 offset:14336
    ds_read_b128 v[40:43], v66 offset:15360
    s_waitcnt lgkmcnt(7)
    v_mfma_f32_32x32x16_bf16 v[76:91], v[168:171], v[12:15], v[76:91]
    s_waitcnt lgkmcnt(6)
    v_mfma_f32_32x32x16_bf16 v[76:91], v[172:175], v[16:19], v[76:91]
    s_waitcnt lgkmcnt(5)
    v_mfma_f32_32x32x16_bf16 v[76:91], v[176:179], v[20:23], v[76:91]
    s_waitcnt lgkmcnt(4)
    v_mfma_f32_32x32x16_bf16 v[76:91], v[180:183], v[24:27], v[76:91]
    s_waitcnt lgkmcnt(3)
    v_mfma_f32_32x32x16_bf16 v[76:91], v[184:187], v[28:31], v[76:91]
    s_waitcnt lgkmcnt(2)
    v_mfma_f32_32x32x16_bf16 v[76:91], v[188:191], v[32:35], v[76:91]
    s_waitcnt lgkmcnt(1)
    v_mfma_f32_32x32x16_bf16 v[76:91], v[192:195], v[36:39], v[76:91]
    s_waitcnt lgkmcnt(0)
    v_mfma_f32_32x32x16_bf16 v[76:91], v[196:199], v[40:43], v[76:91]
    s_waitcnt vmcnt(2)
    s_barrier
    ds_read_b128 v[12:15], v66 offset:16384
    ds_read_b128 v[16:19], v66 offset:17408
    ds_read_b128 v[20:23], v66 offset:18432
    ds_read_b128 v[24:27], v66 offset:19456
    ds_read_b128 v[28:31], v66 offset:20480
    ds_read_b128 v[32:35], v66 offset:21504
    ds_read_b128 v[36:39], v66 offset:22528
    ds_read_b128 v[40:43], v66 offset:23552
    s_waitcnt lgkmcnt(7)
    v_mfma_f32_32x32x16_bf16 v[76:91], v[200:203], v[12:15], v[76:91]
    s_waitcnt lgkmcnt(6)
    v_mfma_f32_32x32x16_bf16 v[76:91], v[204:207], v[16:19], v[76:91]
    s_waitcnt lgkmcnt(5)
    v_mfma_f32_32x32x16_bf16 v[76:91], v[208:211], v[20:23], v[76:91]
    s_waitcnt lgkmcnt(4)
    v_mfma_f32_32x32x16_bf16 v[76:91], v[212:215], v[24:27], v[76:91]
    s_waitcnt lgkmcnt(3)
    v_mfma_f32_32x32x16_bf16 v[76:91], v[216:219], v[28:31], v[76:91]
    s_waitcnt lgkmcnt(2)
    v_mfma_f32_32x32x16_bf16 v[76:91], v[220:223], v[32:35], v[76:91]
    s_waitcnt lgkmcnt(1)
    v_mfma_f32_32x32x16_bf16 v[76:91], v[224:227], v[36:39], v[76:91]
    s_waitcnt lgkmcnt(0)
    v_mfma_f32_32x32x16_bf16 v[76:91], v[228:231], v[40:43], v[76:91]
    s_waitcnt vmcnt(0)
    s_barrier
    ds_read_b128 v[12:15], v66 offset:24576
    ds_read_b128 v[16:19], v66 offset:25600
    ds_read_b128 v[20:23], v66 offset:26624
    ds_read_b128 v[24:27], v66 offset:27648
    ds_read_b128 v[28:31], v66 offset:28672
    ds_read_b128 v[32:35], v66 offset:29696
    ds_read_b128 v[36:39], v66 offset:30720
    ds_read_b128 v[40:43], v66 offset:31744
    s_waitcnt lgkmcnt(7)
    v_mfma_f32_32x32x16_bf16 v[76:91], v[232:235], v[12:15], v[76:91]
    s_waitcnt lgkmcnt(6)
    v_mfma_f32_32x32x16_bf16 v[76:91], v[236:239], v[16:19], v[76:91]
    s_waitcnt lgkmcnt(5)
    v_mfma_f32_32x32x16_bf16 v[76:91], v[240:243], v[20:23], v[76:91]
    s_waitcnt lgkmcnt(4)
    v_mfma_f32_32x32x16_bf16 v[76:91], v[244:247], v[24:27], v[76:91]
    s_waitcnt lgkmcnt(3)
    v_mfma_f32_32x32x16_bf16 v[76:91], v[248:251], v[28:31], v[76:91]
    s_waitcnt lgkmcnt(2)
    v_mfma_f32_32x32x16_bf16 v[76:91], v[108:111], v[32:35], v[76:91]
    s_waitcnt lgkmcnt(1)
    v_mfma_f32_32x32x16_bf16 v[76:91], v[112:115], v[36:39], v[76:91]
    s_waitcnt lgkmcnt(0)
    v_mfma_f32_32x32x16_bf16 v[76:91], v[116:119], v[40:43], v[76:91]
    s_nop 15
    s_cmp_eq_u32 s69, 0
    s_cbranch_scc0 L_x_b1
    ds_write_b128 v63, v[84:87] offset:0
    ds_write_b128 v63, v[88:91] offset:1024
    s_waitcnt lgkmcnt(0)
    s_barrier
    ds_read_b128 v[28:31], v64 offset:0
    ds_read_b128 v[32:35], v64 offset:1024
    s_waitcnt lgkmcnt(0)
    v_pk_add_f32 v[28:29], v[28:29], v[76:77]
    v_pk_add_f32 v[30:31], v[30:31], v[78:79]
    v_pk_add_f32 v[32:33], v[32:33], v[80:81]
    v_pk_add_f32 v[34:35], v[34:35], v[82:83]
    s_branch L_x_j
L_x_b1:
    ds_write_b128 v63, v[76:79] offset:0
    ds_write_b128 v63, v[80:83] offset:1024
    s_waitcnt lgkmcnt(0)
    s_barrier
    ds_read_b128 v[28:31], v64 offset:0
    ds_read_b128 v[32:35], v64 offset:1024
    s_waitcnt lgkmcnt(0)
    v_pk_add_f32 v[28:29], v[28:29], v[84:85]
    v_pk_add_f32 v[30:31], v[30:31], v[86:87]
    v_pk_add_f32 v[32:33], v[32:33], v[88:89]
    v_pk_add_f32 v[34:35], v[34:35], v[90:91]
L_x_j:
    v_cvt_pk_bf16_f32 v48, v28, v29
    v_cvt_pk_bf16_f32 v49, v30, v31
    v_cvt_pk_bf16_f32 v50, v32, v33
    v_cvt_pk_bf16_f32 v51, v34, v35
    s_nop 1
    v_permlane32_swap_b32 v48, v50
    v_permlane32_swap_b32 v49, v51
    buffer_store_dwordx4 v[48:51], v67, s[56:59], 0 offen
L_end:
    s_endpgm
.section .rodata,"a"
.p2align 6
.amdhsa_kernel gated_mix__grouped_kv_mqa__grouped_kv_mqa__prompt_kernel
  .amdhsa_next_free_vgpr 256
  .amdhsa_next_free_sgpr 100
  .amdhsa_accum_offset 256
  .amdhsa_group_segment_fixed_size 0
  .amdhsa_kernarg_size 112
  .amdhsa_user_sgpr_count 2
  .amdhsa_user_sgpr_kernarg_segment_ptr 1
  .amdhsa_system_sgpr_workgroup_id_x 1
  .amdhsa_float_denorm_mode_32 3
.end_amdhsa_kernel
```
